```python
import torch

def _softmax(x, axis=-1):
    return torch.softmax(x, dim=axis)
def _gelu(x):
    return torch.nn.functional.gelu(x, approximate="tanh")
def _silu(x):
    return torch.nn.functional.silu(x)
def _sigmoid(x):
    return torch.sigmoid(x)
def _layernorm(x, axis=-1, eps=1e-5):
    m = x.mean(dim=axis, keepdim=True)
    v = x.var(dim=axis, keepdim=True, unbiased=False)
    return (x - m) / torch.sqrt(v + eps)
def _scatter_add(tgt, idx, src, axis=0):
    return tgt.clone().index_add_(axis, idx, src)
def _segment_sum(src, seg, n):
    out = torch.zeros((n,) + src.shape[1:], dtype=src.dtype)
    return out.index_add_(0, seg, src)
def _pad(x, pw):
    flat = tuple(v for pair in reversed(pw) for v in pair)
    return torch.nn.functional.pad(x, flat)

kernel_name = 'sequential_preLN__gqa_block_cached__dense_activation_relu__decode'

def setup_inputs():

    _w = (lambda a: (lambda t: t.to(torch.bfloat16) if t.is_floating_point() else t)(torch.as_tensor(a)))
    def _A_setup():
        B, Sq, D = 2, 1, 640
        Hq, Hkv, Sk, Dh = 32, 32, 4096, 128
        assert Hq % Hkv == 0, (Hq, Hkv)
        return {
            "x": _w((lambda *s: torch.randn(*s, dtype=torch.bfloat16) * 0.05)(B, Sq, D)),
            "k_cache": _w((lambda *s: torch.randn(*s, dtype=torch.bfloat16) * 3.2)(B, Hkv, Sk, Dh)),
            "v_cache": _w((lambda *s: torch.randn(*s, dtype=torch.bfloat16) * 0.4)(B, Hkv, Sk, Dh)),
            "wq": _w((lambda *s: torch.randn(*s, dtype=torch.bfloat16) * 3.2)(D, Hq * Dh) * (D ** -0.5)),
            "wo": _w((lambda *s: torch.randn(*s, dtype=torch.bfloat16) * 0.4)(Hq * Dh, D) * ((Hq * Dh) ** -0.5)),
        }
    _A_in = _A_setup()

    def _B_setup():
        B, S, D, Dff = 2, 1, 640, 1728
        return {
            "x": _w((lambda *s: torch.randn(*s, dtype=torch.bfloat16) * 0.05)(B, S, D)),
            "w1": _w((lambda *s: torch.randn(*s, dtype=torch.bfloat16) * 0.05)(D, Dff)),
            "w2": _w((lambda *s: torch.randn(*s, dtype=torch.bfloat16) * 0.05)(Dff, D)),
        }
    _B_in = _B_setup()

    return {
        "A_x": _A_in["x"],
        "A_k_cache": _A_in["k_cache"],
        "A_v_cache": _A_in["v_cache"],
        "A_wq": _A_in["wq"],
        "A_wo": _A_in["wo"],
        "B_x": _B_in["x"],
        "B_w1": _B_in["w1"],
        "B_w2": _B_in["w2"],
    }

def reference(A_x, A_k_cache, A_v_cache, A_wq, A_wo, B_x, B_w1, B_w2):
    def _A_ref(x, k_cache, v_cache, wq, wo):
        B, Sq, D = x.shape
        Hq, Dh = 32, 128
        Hkv = k_cache.shape[1]
        rep = Hq // Hkv
        q = (lambda x, *d: x.permute(*d))((x @ wq).reshape(B, Sq, Hq, Dh), 0, 2, 1, 3)
        k = (lambda x, n, axis: torch.repeat_interleave(x, n, dim=axis))(k_cache, rep, axis=1)
        v = (lambda x, n, axis: torch.repeat_interleave(x, n, dim=axis))(v_cache, rep, axis=1)
        scores = torch.einsum("bhqd,bhkd->bhqk", q, k) * (Dh ** -0.5)
        p = _softmax(scores, axis=-1)
        o = torch.einsum("bhqk,bhkd->bhqd", p, v)
        return (lambda x, *d: x.permute(*d))(o, 0, 2, 1, 3).reshape(B, Sq, Hq * Dh) @ wo

    def _B_ref(x, w1, w2):
        h = torch.einsum("bsd,df->bsf", x, w1)
        zero = torch.zeros_like(h)
        h = torch.maximum(h, zero)
        return torch.einsum("bsf,fd->bsd", h, w2)

    x = A_x
    h = x + _A_ref(_layernorm(x, axis=-1), A_k_cache, A_v_cache, A_wq, A_wo)
    h2 = h + _B_ref(_layernorm(h, axis=-1), B_w1, B_w2)
    return h2
```

```asm
; @launch grid=(256,1,1) block=(512,1,1) lds=29568
.amdgcn_target "amdgcn-amd-amdhsa--gfx950"
.text
.globl sequential_preLN__gqa_block_cached__dense_activation_relu__decode_kernel
.p2align 8
.type sequential_preLN__gqa_block_cached__dense_activation_relu__decode_kernel,@function
sequential_preLN__gqa_block_cached__dense_activation_relu__decode_kernel:
    s_cmp_ge_u32 s2, 256
    s_cbranch_scc1 L_end2
    s_load_dwordx2 s[32:33], s[0:1], 0
    s_load_dwordx2 s[4:5], s[0:1], 8
    s_load_dwordx2 s[8:9], s[0:1], 16
    s_load_dwordx2 s[12:13], s[0:1], 24
    s_load_dwordx2 s[16:17], s[0:1], 32
    s_load_dwordx2 s[20:21], s[0:1], 48
    s_load_dwordx2 s[24:25], s[0:1], 56
    s_load_dwordx2 s[34:35], s[0:1], 64
    s_load_dwordx2 s[36:37], s[0:1], 72
    s_load_dwordx2 s[28:29], s[0:1], 80
    s_and_b32 s39, s2, 7
    s_lshl_b32 s39, s39, 2
    s_lshr_b32 s3, s2, 3
    s_and_b32 s3, s3, 3
    s_or_b32 s39, s39, s3
    s_lshr_b32 s3, s2, 5
    s_lshr_b32 s38, s3, 2
    s_and_b32 s40, s3, 3
    s_lshl_b32 s42, s39, 2
    s_or_b32 s42, s42, s40
    v_lshrrev_b32 v1, 6, v0
    s_nop 0
    v_readfirstlane_b32 s41, v1
    v_and_b32 v1, 63, v0
    v_lshrrev_b32 v3, 4, v1
    v_and_b32 v4, 15, v1
    s_mov_b32 s43, 0x05040100
    s_mov_b32 s44, 0x07060302
    s_mov_b32 s60, 0
    s_mov_b32 s70, 0
    s_mov_b32 s78, 0
    s_mov_b32 s86, 0
    s_mov_b32 s61, 4096
    s_mov_b32 s71, 8192
    s_mov_b32 s79, 1280
    s_mov_b32 s87, 3456
    s_mov_b32 s62, 8192
    s_mov_b32 s72, 16384
    s_mov_b32 s80, 2560
    s_mov_b32 s88, 6912
    s_mov_b32 s63, 12288
    s_mov_b32 s73, 24576
    s_mov_b32 s81, 3840
    s_mov_b32 s89, 10368
    s_mov_b32 s64, 16384
    s_mov_b32 s74, 32768
    s_mov_b32 s82, 5120
    s_mov_b32 s90, 13824
    s_mov_b32 s65, 20480
    s_mov_b32 s75, 40960
    s_mov_b32 s83, 6400
    s_mov_b32 s91, 17280
    s_mov_b32 s66, 24576
    s_mov_b32 s76, 49152
    s_mov_b32 s84, 7680
    s_mov_b32 s92, 20736
    s_mov_b32 s67, 28672
    s_mov_b32 s77, 57344
    s_mov_b32 s85, 8960
    s_mov_b32 s93, 24192
    s_mov_b32 s54, 0xcccccccc
    s_mov_b32 s55, 0xcccccccc
    s_mov_b32 s56, 0
    s_mov_b32 s57, -1
    v_lshlrev_b32 v2, 4, v1
    s_lshl_b32 s3, s41, 15
    v_add_u32 v2, s3, v2
    s_waitcnt lgkmcnt(0)
    s_lshl_b32 s3, s38, 5
    s_add_u32 s3, s3, s39
    s_lshl_b32 s3, s3, 20
    s_lshl_b32 s45, s40, 18
    s_add_u32 s3, s3, s45
    s_add_u32 s4, s4, s3
    s_addc_u32 s5, s5, 0
    s_mov_b32 s6, 262144
    s_mov_b32 s7, 0x20000
    s_add_u32 s8, s8, s3
    s_addc_u32 s9, s9, 0
    s_mov_b32 s10, 262144
    s_mov_b32 s11, 0x20000
    s_lshl_b32 s3, s39, 8
    s_add_u32 s12, s12, s3
    s_addc_u32 s13, s13, 0
    s_sub_u32 s14, 5242880, s3
    s_mov_b32 s15, 0x20000
    s_mul_i32 s3, s39, 163840
    s_add_u32 s16, s16, s3
    s_addc_u32 s17, s17, 0
    s_mov_b32 s18, 163840
    s_mov_b32 s19, 0x20000
    s_mov_b32 s22, 2211840
    s_mov_b32 s23, 0x20000
    s_mov_b32 s26, 2211840
    s_mov_b32 s27, 0x20000
    s_mov_b32 s30, 0x100000
    s_mov_b32 s31, 0x20000
    s_mul_i32 s3, s38, 1280
    s_add_u32 s32, s32, s3
    s_addc_u32 s33, s33, 0
    v_mov_b32 v12, 0
    v_mov_b32 v13, 0
    v_mov_b32 v14, 0
    v_mov_b32 v15, 0
    v_lshrrev_b32 v9, 2, v0
    s_mul_i32 s3, s38, 40
    v_add_u32 v9, s3, v9
    v_lshlrev_b32 v9, 13, v9
    s_lshl_b32 s3, s42, 6
    v_add_u32 v9, s3, v9
    v_and_b32 v10, 3, v0
    v_lshlrev_b32 v10, 4, v10
    v_add_u32 v9, v9, v10
    v_cmp_gt_u32 vcc, 160, v0
    v_mov_b32 v11, 0x80000000
    s_nop 0
    v_cndmask_b32 v9, v11, v9, vcc
    v_subrev_u32 v10, 160, v0
    v_lshlrev_b32 v16, 4, v10
    s_lshl_b32 s3, s2, 6
    s_add_u32 s3, s3, 659456
    v_add_u32 v16, s3, v16
    s_cmp_lt_u32 s2, 80
    s_cselect_b32 s45, 4, 0
    v_cmp_gt_u32 vcc, s45, v10
    s_nop 1
    v_cndmask_b32 v9, v9, v16, vcc
    buffer_store_dwordx4 v[12:15], v9, s[28:31], 0 offen sc1
    s_sub_u32 s45, s2, 80
    v_lshrrev_b32 v9, 3, v0
    v_mul_u32_u24 v9, 54, v9
    v_add_u32 v9, s45, v9
    v_lshlrev_b32 v9, 7, v9
    v_and_b32 v10, 7, v0
    v_lshlrev_b32 v10, 4, v10
    v_add_u32 v9, v9, v10
    v_add_u32 v9, 671744, v9
    s_cmp_lt_u32 s45, 54
    s_cselect_b32 s45, 320, 0
    v_cmp_gt_u32 vcc, s45, v0
    v_mov_b32 v11, 0x80000000
    s_nop 0
    v_cndmask_b32 v9, v11, v9, vcc
    buffer_store_dwordx4 v[12:15], v9, s[28:31], 0 offen sc1
    s_lshl_b32 s3, s38, 7
    s_add_u32 s3, s3, s42
    s_lshl_b32 s3, s3, 3
    s_add_u32 s47, s3, 655360
    v_mov_b32 v9, s47
    v_cmp_eq_u32 vcc, 0, v0
    v_mov_b32 v11, 0x80000000
    s_nop 0
    v_cndmask_b32 v9, v11, v9, vcc
    buffer_store_dwordx2 v[12:13], v9, s[28:31], 0 offen sc1
    v_lshlrev_b32 v9, 2, v1
    global_load_dword v24, v9, s[32:33] offset:0
    global_load_dword v25, v9, s[32:33] offset:256
    global_load_dword v26, v9, s[32:33] offset:512
    global_load_dword v27, v9, s[32:33] offset:768
    global_load_dword v28, v9, s[32:33] offset:1024
    s_add_u32 s3, s41, 0
    s_lshl_b32 s45, s3, 18
    s_cmp_lt_u32 s3, 20
    s_cselect_b32 s45, s45, 0x80000000
    v_lshlrev_b32 v9, 16, v3
    v_lshl_add_u32 v9, v4, 4, v9
    v_or_b32 v9, s45, v9
    buffer_load_dwordx4 v[128:131], v9, s[12:15], s70 offen offset:0
    buffer_load_dwordx4 v[132:135], v9, s[12:15], s71 offen offset:0
    buffer_load_dwordx4 v[136:139], v9, s[12:15], s72 offen offset:0
    buffer_load_dwordx4 v[140:143], v9, s[12:15], s73 offen offset:0
    buffer_load_dwordx4 v[144:147], v9, s[12:15], s74 offen offset:0
    buffer_load_dwordx4 v[148:151], v9, s[12:15], s75 offen offset:0
    buffer_load_dwordx4 v[152:155], v9, s[12:15], s76 offen offset:0
    buffer_load_dwordx4 v[156:159], v9, s[12:15], s77 offen offset:0
    s_add_u32 s3, s41, 8
    s_lshl_b32 s45, s3, 18
    s_cmp_lt_u32 s3, 20
    s_cselect_b32 s45, s45, 0x80000000
    v_lshlrev_b32 v9, 16, v3
    v_lshl_add_u32 v9, v4, 4, v9
    v_or_b32 v9, s45, v9
    buffer_load_dwordx4 v[160:163], v9, s[12:15], s70 offen offset:0
    buffer_load_dwordx4 v[164:167], v9, s[12:15], s71 offen offset:0
    buffer_load_dwordx4 v[168:171], v9, s[12:15], s72 offen offset:0
    buffer_load_dwordx4 v[172:175], v9, s[12:15], s73 offen offset:0
    buffer_load_dwordx4 v[176:179], v9, s[12:15], s74 offen offset:0
    buffer_load_dwordx4 v[180:183], v9, s[12:15], s75 offen offset:0
    buffer_load_dwordx4 v[184:187], v9, s[12:15], s76 offen offset:0
    buffer_load_dwordx4 v[188:191], v9, s[12:15], s77 offen offset:0
    s_add_u32 s3, s41, 16
    s_lshl_b32 s45, s3, 18
    s_cmp_lt_u32 s3, 20
    s_cselect_b32 s45, s45, 0x80000000
    v_lshlrev_b32 v9, 16, v3
    v_lshl_add_u32 v9, v4, 4, v9
    v_or_b32 v9, s45, v9
    buffer_load_dwordx4 v[192:195], v9, s[12:15], s70 offen offset:0
    buffer_load_dwordx4 v[196:199], v9, s[12:15], s71 offen offset:0
    buffer_load_dwordx4 v[200:203], v9, s[12:15], s72 offen offset:0
    buffer_load_dwordx4 v[204:207], v9, s[12:15], s73 offen offset:0
    buffer_load_dwordx4 v[208:211], v9, s[12:15], s74 offen offset:0
    buffer_load_dwordx4 v[212:215], v9, s[12:15], s75 offen offset:0
    buffer_load_dwordx4 v[216:219], v9, s[12:15], s76 offen offset:0
    buffer_load_dwordx4 v[220:223], v9, s[12:15], s77 offen offset:0
    buffer_load_dwordx4 v[32:35], v2, s[4:7], s60 offen offset:0 nt
    buffer_load_dwordx4 v[36:39], v2, s[4:7], s60 offen offset:1024 nt
    buffer_load_dwordx4 v[40:43], v2, s[4:7], s60 offen offset:2048 nt
    buffer_load_dwordx4 v[44:47], v2, s[4:7], s60 offen offset:3072 nt
    buffer_load_dwordx4 v[48:51], v2, s[4:7], s61 offen offset:0 nt
    buffer_load_dwordx4 v[52:55], v2, s[4:7], s61 offen offset:1024 nt
    buffer_load_dwordx4 v[56:59], v2, s[4:7], s61 offen offset:2048 nt
    buffer_load_dwordx4 v[60:63], v2, s[4:7], s61 offen offset:3072 nt
    buffer_load_dwordx4 v[64:67], v2, s[4:7], s62 offen offset:0 nt
    buffer_load_dwordx4 v[68:71], v2, s[4:7], s62 offen offset:1024 nt
    buffer_load_dwordx4 v[72:75], v2, s[4:7], s62 offen offset:2048 nt
    buffer_load_dwordx4 v[76:79], v2, s[4:7], s62 offen offset:3072 nt
    buffer_load_dwordx4 v[80:83], v2, s[4:7], s63 offen offset:0 nt
    buffer_load_dwordx4 v[84:87], v2, s[4:7], s63 offen offset:1024 nt
    buffer_load_dwordx4 v[88:91], v2, s[4:7], s63 offen offset:2048 nt
    buffer_load_dwordx4 v[92:95], v2, s[4:7], s63 offen offset:3072 nt
    buffer_load_dwordx4 v[96:99], v2, s[4:7], s64 offen offset:0 nt
    buffer_load_dwordx4 v[100:103], v2, s[4:7], s64 offen offset:1024 nt
    buffer_load_dwordx4 v[104:107], v2, s[4:7], s64 offen offset:2048 nt
    buffer_load_dwordx4 v[108:111], v2, s[4:7], s64 offen offset:3072 nt
    buffer_load_dwordx4 v[112:115], v2, s[4:7], s65 offen offset:0 nt
    buffer_load_dwordx4 v[116:119], v2, s[4:7], s65 offen offset:1024 nt
    buffer_load_dwordx4 v[120:123], v2, s[4:7], s65 offen offset:2048 nt
    buffer_load_dwordx4 v[124:127], v2, s[4:7], s65 offen offset:3072 nt
    s_waitcnt vmcnt(48)
    v_lshlrev_b32 v224, 16, v24
    v_and_b32 v225, 0xffff0000, v24
    v_lshlrev_b32 v226, 16, v25
    v_and_b32 v227, 0xffff0000, v25
    v_lshlrev_b32 v228, 16, v26
    v_and_b32 v229, 0xffff0000, v26
    v_lshlrev_b32 v230, 16, v27
    v_and_b32 v231, 0xffff0000, v27
    v_lshlrev_b32 v232, 16, v28
    v_and_b32 v233, 0xffff0000, v28
    v_add_f32 v12, v224, v225
    v_add_f32 v12, v12, v226
    v_add_f32 v12, v12, v227
    v_add_f32 v12, v12, v228
    v_add_f32 v12, v12, v229
    v_add_f32 v12, v12, v230
    v_add_f32 v12, v12, v231
    v_add_f32 v12, v12, v232
    v_add_f32 v12, v12, v233
    s_nop 1
    v_add_f32_dpp v12, v12, v12 row_ror:8 row_mask:0xf bank_mask:0xf
    s_nop 1
    v_add_f32_dpp v12, v12, v12 row_ror:4 row_mask:0xf bank_mask:0xf
    s_nop 1
    v_add_f32_dpp v12, v12, v12 row_ror:2 row_mask:0xf bank_mask:0xf
    s_nop 1
    v_add_f32_dpp v12, v12, v12 row_ror:1 row_mask:0xf bank_mask:0xf
    s_nop 1
    v_add_f32_dpp v12, v12, v12 row_bcast:15 row_mask:0xa bank_mask:0xf
    s_nop 1
    v_add_f32_dpp v12, v12, v12 row_bcast:31 row_mask:0xc bank_mask:0xf
    s_nop 1
    v_readlane_b32 s45, v12, 63
    s_nop 1
    v_mov_b32 v13, s45
    v_mul_f32 v13, 0x3acccccd, v13
    v_sub_f32 v14, v224, v13
    v_mul_f32 v12, v14, v14
    v_sub_f32 v14, v225, v13
    v_fmac_f32 v12, v14, v14
    v_sub_f32 v14, v226, v13
    v_fmac_f32 v12, v14, v14
    v_sub_f32 v14, v227, v13
    v_fmac_f32 v12, v14, v14
    v_sub_f32 v14, v228, v13
    v_fmac_f32 v12, v14, v14
    v_sub_f32 v14, v229, v13
    v_fmac_f32 v12, v14, v14
    v_sub_f32 v14, v230, v13
    v_fmac_f32 v12, v14, v14
    v_sub_f32 v14, v231, v13
    v_fmac_f32 v12, v14, v14
    v_sub_f32 v14, v232, v13
    v_fmac_f32 v12, v14, v14
    v_sub_f32 v14, v233, v13
    v_fmac_f32 v12, v14, v14
    s_nop 1
    v_add_f32_dpp v12, v12, v12 row_ror:8 row_mask:0xf bank_mask:0xf
    s_nop 1
    v_add_f32_dpp v12, v12, v12 row_ror:4 row_mask:0xf bank_mask:0xf
    s_nop 1
    v_add_f32_dpp v12, v12, v12 row_ror:2 row_mask:0xf bank_mask:0xf
    s_nop 1
    v_add_f32_dpp v12, v12, v12 row_ror:1 row_mask:0xf bank_mask:0xf
    s_nop 1
    v_add_f32_dpp v12, v12, v12 row_bcast:15 row_mask:0xa bank_mask:0xf
    s_nop 1
    v_add_f32_dpp v12, v12, v12 row_bcast:31 row_mask:0xc bank_mask:0xf
    s_nop 1
    v_readlane_b32 s45, v12, 63
    s_nop 1
    v_mov_b32 v14, s45
    v_mul_f32 v14, 0x3acccccd, v14
    v_cvt_pk_bf16_f32 v14, v14, v14
    v_and_b32 v14, 0xffff0000, v14
    v_add_f32 v14, 0x3727c5ac, v14
    v_cvt_pk_bf16_f32 v14, v14, v14
    v_and_b32 v14, 0xffff0000, v14
    v_sqrt_f32 v14, v14
    s_nop 0
    v_cvt_pk_bf16_f32 v14, v14, v14
    v_and_b32 v14, 0xffff0000, v14
    v_rcp_f32 v15, v14
    v_cvt_pk_bf16_f32 v13, v13, v13
    v_and_b32 v13, 0xffff0000, v13
    v_sub_f32 v224, v224, v13
    v_cvt_pk_bf16_f32 v224, v224, v224
    v_and_b32 v224, 0xffff0000, v224
    v_mul_f32 v16, v224, v15
    v_fma_f32 v17, -v16, v14, v224
    v_fma_f32 v224, v17, v15, v16
    v_sub_f32 v225, v225, v13
    v_cvt_pk_bf16_f32 v225, v225, v225
    v_and_b32 v225, 0xffff0000, v225
    v_mul_f32 v16, v225, v15
    v_fma_f32 v17, -v16, v14, v225
    v_fma_f32 v225, v17, v15, v16
    v_sub_f32 v226, v226, v13
    v_cvt_pk_bf16_f32 v226, v226, v226
    v_and_b32 v226, 0xffff0000, v226
    v_mul_f32 v16, v226, v15
    v_fma_f32 v17, -v16, v14, v226
    v_fma_f32 v226, v17, v15, v16
    v_sub_f32 v227, v227, v13
    v_cvt_pk_bf16_f32 v227, v227, v227
    v_and_b32 v227, 0xffff0000, v227
    v_mul_f32 v16, v227, v15
    v_fma_f32 v17, -v16, v14, v227
    v_fma_f32 v227, v17, v15, v16
    v_sub_f32 v228, v228, v13
    v_cvt_pk_bf16_f32 v228, v228, v228
    v_and_b32 v228, 0xffff0000, v228
    v_mul_f32 v16, v228, v15
    v_fma_f32 v17, -v16, v14, v228
    v_fma_f32 v228, v17, v15, v16
    v_sub_f32 v229, v229, v13
    v_cvt_pk_bf16_f32 v229, v229, v229
    v_and_b32 v229, 0xffff0000, v229
    v_mul_f32 v16, v229, v15
    v_fma_f32 v17, -v16, v14, v229
    v_fma_f32 v229, v17, v15, v16
    v_sub_f32 v230, v230, v13
    v_cvt_pk_bf16_f32 v230, v230, v230
    v_and_b32 v230, 0xffff0000, v230
    v_mul_f32 v16, v230, v15
    v_fma_f32 v17, -v16, v14, v230
    v_fma_f32 v230, v17, v15, v16
    v_sub_f32 v231, v231, v13
    v_cvt_pk_bf16_f32 v231, v231, v231
    v_and_b32 v231, 0xffff0000, v231
    v_mul_f32 v16, v231, v15
    v_fma_f32 v17, -v16, v14, v231
    v_fma_f32 v231, v17, v15, v16
    v_sub_f32 v232, v232, v13
    v_cvt_pk_bf16_f32 v232, v232, v232
    v_and_b32 v232, 0xffff0000, v232
    v_mul_f32 v16, v232, v15
    v_fma_f32 v17, -v16, v14, v232
    v_fma_f32 v232, v17, v15, v16
    v_sub_f32 v233, v233, v13
    v_cvt_pk_bf16_f32 v233, v233, v233
    v_and_b32 v233, 0xffff0000, v233
    v_mul_f32 v16, v233, v15
    v_fma_f32 v17, -v16, v14, v233
    v_fma_f32 v233, v17, v15, v16
    v_lshlrev_b32 v9, 2, v1
    v_cvt_pk_bf16_f32 v24, v224, v225
    ds_write_b32 v9, v24 offset:0
    v_cvt_pk_bf16_f32 v25, v226, v227
    ds_write_b32 v9, v25 offset:256
    v_cvt_pk_bf16_f32 v26, v228, v229
    ds_write_b32 v9, v26 offset:512
    v_cvt_pk_bf16_f32 v27, v230, v231
    ds_write_b32 v9, v27 offset:768
    v_cvt_pk_bf16_f32 v28, v232, v233
    ds_write_b32 v9, v28 offset:1024
    s_waitcnt lgkmcnt(0)
    s_add_u32 s3, s41, 0
    s_cmp_lt_u32 s3, 20
    s_cselect_b32 s3, s3, 0
    s_lshl_b32 s3, s3, 6
    v_lshlrev_b32 v9, 4, v3
    v_add_u32 v9, s3, v9
    ds_read_b128 v[24:27], v9 offset:0
    s_waitcnt vmcnt(40)
    s_waitcnt lgkmcnt(0)
    v_perm_b32 v12, v132, v128, s43
    v_perm_b32 v13, v140, v136, s43
    v_perm_b32 v14, v148, v144, s43
    v_perm_b32 v15, v156, v152, s43
    v_perm_b32 v16, v132, v128, s44
    v_perm_b32 v17, v140, v136, s44
    v_perm_b32 v18, v148, v144, s44
    v_perm_b32 v19, v156, v152, s44
    v_mfma_f32_16x16x32_bf16 v[224:227], v[24:27], v[12:15], 0
    v_perm_b32 v20, v133, v129, s43
    v_perm_b32 v21, v141, v137, s43
    v_perm_b32 v22, v149, v145, s43
    v_perm_b32 v23, v157, v153, s43
    v_mfma_f32_16x16x32_bf16 v[228:231], v[24:27], v[16:19], 0
    v_perm_b32 v12, v133, v129, s44
    v_perm_b32 v13, v141, v137, s44
    v_perm_b32 v14, v149, v145, s44
    v_perm_b32 v15, v157, v153, s44
    v_mfma_f32_16x16x32_bf16 v[232:235], v[24:27], v[20:23], 0
    v_perm_b32 v16, v134, v130, s43
    v_perm_b32 v17, v142, v138, s43
    v_perm_b32 v18, v150, v146, s43
    v_perm_b32 v19, v158, v154, s43
    v_mfma_f32_16x16x32_bf16 v[236:239], v[24:27], v[12:15], 0
    v_perm_b32 v20, v134, v130, s44
    v_perm_b32 v21, v142, v138, s44
    v_perm_b32 v22, v150, v146, s44
    v_perm_b32 v23, v158, v154, s44
    v_mfma_f32_16x16x32_bf16 v[240:243], v[24:27], v[16:19], 0
    v_perm_b32 v12, v135, v131, s43
    v_perm_b32 v13, v143, v139, s43
    v_perm_b32 v14, v151, v147, s43
    v_perm_b32 v15, v159, v155, s43
    v_mfma_f32_16x16x32_bf16 v[244:247], v[24:27], v[20:23], 0
    v_perm_b32 v16, v135, v131, s44
    v_perm_b32 v17, v143, v139, s44
    v_perm_b32 v18, v151, v147, s44
    v_perm_b32 v19, v159, v155, s44
    v_mfma_f32_16x16x32_bf16 v[248:251], v[24:27], v[12:15], 0
    s_nop 1
    v_mfma_f32_16x16x32_bf16 v[252:255], v[24:27], v[16:19], 0
    s_add_u32 s3, s41, 8
    s_cmp_lt_u32 s3, 20
    s_cselect_b32 s3, s3, 0
    s_lshl_b32 s3, s3, 6
    v_lshlrev_b32 v9, 4, v3
    v_add_u32 v9, s3, v9
    ds_read_b128 v[24:27], v9 offset:0
    s_waitcnt vmcnt(32)
    s_waitcnt lgkmcnt(0)
    v_perm_b32 v12, v164, v160, s43
    v_perm_b32 v13, v172, v168, s43
    v_perm_b32 v14, v180, v176, s43
    v_perm_b32 v15, v188, v184, s43
    v_perm_b32 v16, v164, v160, s44
    v_perm_b32 v17, v172, v168, s44
    v_perm_b32 v18, v180, v176, s44
    v_perm_b32 v19, v188, v184, s44
    v_mfma_f32_16x16x32_bf16 v[224:227], v[24:27], v[12:15], v[224:227]
    v_perm_b32 v20, v165, v161, s43
    v_perm_b32 v21, v173, v169, s43
    v_perm_b32 v22, v181, v177, s43
    v_perm_b32 v23, v189, v185, s43
    v_mfma_f32_16x16x32_bf16 v[228:231], v[24:27], v[16:19], v[228:231]
    v_perm_b32 v12, v165, v161, s44
    v_perm_b32 v13, v173, v169, s44
    v_perm_b32 v14, v181, v177, s44
    v_perm_b32 v15, v189, v185, s44
    v_mfma_f32_16x16x32_bf16 v[232:235], v[24:27], v[20:23], v[232:235]
    v_perm_b32 v16, v166, v162, s43
    v_perm_b32 v17, v174, v170, s43
    v_perm_b32 v18, v182, v178, s43
    v_perm_b32 v19, v190, v186, s43
    v_mfma_f32_16x16x32_bf16 v[236:239], v[24:27], v[12:15], v[236:239]
    v_perm_b32 v20, v166, v162, s44
    v_perm_b32 v21, v174, v170, s44
    v_perm_b32 v22, v182, v178, s44
    v_perm_b32 v23, v190, v186, s44
    v_mfma_f32_16x16x32_bf16 v[240:243], v[24:27], v[16:19], v[240:243]
    v_perm_b32 v12, v167, v163, s43
    v_perm_b32 v13, v175, v171, s43
    v_perm_b32 v14, v183, v179, s43
    v_perm_b32 v15, v191, v187, s43
    v_mfma_f32_16x16x32_bf16 v[244:247], v[24:27], v[20:23], v[244:247]
    v_perm_b32 v16, v167, v163, s44
    v_perm_b32 v17, v175, v171, s44
    v_perm_b32 v18, v183, v179, s44
    v_perm_b32 v19, v191, v187, s44
    v_mfma_f32_16x16x32_bf16 v[248:251], v[24:27], v[12:15], v[248:251]
    s_nop 1
    v_mfma_f32_16x16x32_bf16 v[252:255], v[24:27], v[16:19], v[252:255]
    s_add_u32 s3, s41, 16
    s_cmp_lt_u32 s3, 20
    s_cselect_b32 s3, s3, 0
    s_lshl_b32 s3, s3, 6
    v_lshlrev_b32 v9, 4, v3
    v_add_u32 v9, s3, v9
    ds_read_b128 v[24:27], v9 offset:0
    s_waitcnt vmcnt(24)
    s_waitcnt lgkmcnt(0)
    v_perm_b32 v12, v196, v192, s43
    v_perm_b32 v13, v204, v200, s43
    v_perm_b32 v14, v212, v208, s43
    v_perm_b32 v15, v220, v216, s43
    v_perm_b32 v16, v196, v192, s44
    v_perm_b32 v17, v204, v200, s44
    v_perm_b32 v18, v212, v208, s44
    v_perm_b32 v19, v220, v216, s44
    v_mfma_f32_16x16x32_bf16 v[224:227], v[24:27], v[12:15], v[224:227]
    v_perm_b32 v20, v197, v193, s43
    v_perm_b32 v21, v205, v201, s43
    v_perm_b32 v22, v213, v209, s43
    v_perm_b32 v23, v221, v217, s43
    v_mfma_f32_16x16x32_bf16 v[228:231], v[24:27], v[16:19], v[228:231]
    v_perm_b32 v12, v197, v193, s44
    v_perm_b32 v13, v205, v201, s44
    v_perm_b32 v14, v213, v209, s44
    v_perm_b32 v15, v221, v217, s44
    v_mfma_f32_16x16x32_bf16 v[232:235], v[24:27], v[20:23], v[232:235]
    v_perm_b32 v16, v198, v194, s43
    v_perm_b32 v17, v206, v202, s43
    v_perm_b32 v18, v214, v210, s43
    v_perm_b32 v19, v222, v218, s43
    v_mfma_f32_16x16x32_bf16 v[236:239], v[24:27], v[12:15], v[236:239]
    v_perm_b32 v20, v198, v194, s44
    v_perm_b32 v21, v206, v202, s44
    v_perm_b32 v22, v214, v210, s44
    v_perm_b32 v23, v222, v218, s44
    v_mfma_f32_16x16x32_bf16 v[240:243], v[24:27], v[16:19], v[240:243]
    v_perm_b32 v12, v199, v195, s43
    v_perm_b32 v13, v207, v203, s43
    v_perm_b32 v14, v215, v211, s43
    v_perm_b32 v15, v223, v219, s43
    v_mfma_f32_16x16x32_bf16 v[244:247], v[24:27], v[20:23], v[244:247]
    v_perm_b32 v16, v199, v195, s44
    v_perm_b32 v17, v207, v203, s44
    v_perm_b32 v18, v215, v211, s44
    v_perm_b32 v19, v223, v219, s44
    v_mfma_f32_16x16x32_bf16 v[248:251], v[24:27], v[12:15], v[248:251]
    s_nop 1
    v_mfma_f32_16x16x32_bf16 v[252:255], v[24:27], v[16:19], v[252:255]
    s_lshl_b32 s3, s41, 9
    v_lshlrev_b32 v10, 5, v4
    v_add_u32 v10, s3, v10
    v_add_u32 v10, 2560, v10
    s_nop 7
    s_nop 1
    s_mov_b64 exec, 0xffff
    ds_write2_b32 v10, v224, v228 offset0:0 offset1:1
    ds_write2_b32 v10, v232, v236 offset0:2 offset1:3
    ds_write2_b32 v10, v240, v244 offset0:4 offset1:5
    ds_write2_b32 v10, v248, v252 offset0:6 offset1:7
    s_mov_b64 exec, -1
    s_waitcnt lgkmcnt(0)
    buffer_load_dwordx4 v[224:227], v2, s[4:7], s66 offen offset:0 nt
    buffer_load_dwordx4 v[228:231], v2, s[4:7], s66 offen offset:1024 nt
    buffer_load_dwordx4 v[232:235], v2, s[4:7], s66 offen offset:2048 nt
    buffer_load_dwordx4 v[236:239], v2, s[4:7], s66 offen offset:3072 nt
    buffer_load_dwordx4 v[240:243], v2, s[4:7], s67 offen offset:0 nt
    buffer_load_dwordx4 v[244:247], v2, s[4:7], s67 offen offset:1024 nt
    buffer_load_dwordx4 v[248:251], v2, s[4:7], s67 offen offset:2048 nt
    buffer_load_dwordx4 v[252:255], v2, s[4:7], s67 offen offset:3072 nt
    buffer_load_dwordx4 v[128:131], v2, s[8:11], s60 offen offset:0 nt
    buffer_load_dwordx4 v[132:135], v2, s[8:11], s60 offen offset:1024 nt
    buffer_load_dwordx4 v[136:139], v2, s[8:11], s60 offen offset:2048 nt
    buffer_load_dwordx4 v[140:143], v2, s[8:11], s60 offen offset:3072 nt
    buffer_load_dwordx4 v[144:147], v2, s[8:11], s61 offen offset:0 nt
    buffer_load_dwordx4 v[148:151], v2, s[8:11], s61 offen offset:1024 nt
    buffer_load_dwordx4 v[152:155], v2, s[8:11], s61 offen offset:2048 nt
    buffer_load_dwordx4 v[156:159], v2, s[8:11], s61 offen offset:3072 nt
    buffer_load_dwordx4 v[160:163], v2, s[8:11], s62 offen offset:0 nt
    buffer_load_dwordx4 v[164:167], v2, s[8:11], s62 offen offset:1024 nt
    buffer_load_dwordx4 v[168:171], v2, s[8:11], s62 offen offset:2048 nt
    buffer_load_dwordx4 v[172:175], v2, s[8:11], s62 offen offset:3072 nt
    buffer_load_dwordx4 v[176:179], v2, s[8:11], s63 offen offset:0 nt
    buffer_load_dwordx4 v[180:183], v2, s[8:11], s63 offen offset:1024 nt
    buffer_load_dwordx4 v[184:187], v2, s[8:11], s63 offen offset:2048 nt
    buffer_load_dwordx4 v[188:191], v2, s[8:11], s63 offen offset:3072 nt
    buffer_load_dwordx4 v[192:195], v2, s[8:11], s64 offen offset:0 nt
    buffer_load_dwordx4 v[196:199], v2, s[8:11], s64 offen offset:1024 nt
    buffer_load_dwordx4 v[200:203], v2, s[8:11], s64 offen offset:2048 nt
    buffer_load_dwordx4 v[204:207], v2, s[8:11], s64 offen offset:3072 nt
    buffer_load_dwordx4 v[208:211], v2, s[8:11], s65 offen offset:0 nt
    buffer_load_dwordx4 v[212:215], v2, s[8:11], s65 offen offset:1024 nt
    buffer_load_dwordx4 v[216:219], v2, s[8:11], s65 offen offset:2048 nt
    buffer_load_dwordx4 v[220:223], v2, s[8:11], s65 offen offset:3072 nt
    s_barrier
    s_cmp_lg_u32 s41, 0
    s_cbranch_scc1 L_nocnt
    v_mov_b32 v9, 0
    v_mov_b32 v10, 1
    s_mov_b64 exec, 1
    global_atomic_add v9, v10, s[36:37] sc1
    s_mov_b64 exec, -1
L_nocnt:
    s_cmp_ge_u32 s41, 2
    s_cbranch_scc1 L_noq
    v_lshlrev_b32 v9, 2, v0
    ds_read_b32 v12, v9 offset:2560
    ds_read_b32 v13, v9 offset:3072
    ds_read_b32 v14, v9 offset:3584
    ds_read_b32 v15, v9 offset:4096
    ds_read_b32 v16, v9 offset:4608
    ds_read_b32 v17, v9 offset:5120
    ds_read_b32 v18, v9 offset:5632
    ds_read_b32 v19, v9 offset:6144
    s_waitcnt lgkmcnt(0)
    v_add_f32 v12, v12, v13
    v_add_f32 v12, v12, v14
    v_add_f32 v12, v12, v15
    v_add_f32 v12, v12, v16
    v_add_f32 v12, v12, v17
    v_add_f32 v12, v12, v18
    v_add_f32 v12, v12, v19
    v_cvt_pk_bf16_f32 v12, v12, v12
    v_lshlrev_b32 v9, 1, v0
    ds_write_b16 v9, v12 offset:6656
    s_waitcnt lgkmcnt(0)
L_noq:
    s_barrier
    v_lshlrev_b32 v9, 4, v4
    ds_read_b128 v[28:31], v9 offset:6656
    s_waitcnt lgkmcnt(0)
    s_waitcnt vmcnt(48)
    v_dot2_f32_bf16 v12, v32, v28, 0
    v_dot2_f32_bf16 v13, v36, v28, 0
    v_dot2_f32_bf16 v14, v40, v28, 0
    v_dot2_f32_bf16 v15, v44, v28, 0
    v_dot2_f32_bf16 v16, v48, v28, 0
    v_dot2_f32_bf16 v17, v52, v28, 0
    v_dot2_f32_bf16 v18, v56, v28, 0
    v_dot2_f32_bf16 v19, v60, v28, 0
    v_dot2_f32_bf16 v12, v33, v29, v12
    v_dot2_f32_bf16 v13, v37, v29, v13
    v_dot2_f32_bf16 v14, v41, v29, v14
    v_dot2_f32_bf16 v15, v45, v29, v15
    v_dot2_f32_bf16 v16, v49, v29, v16
    v_dot2_f32_bf16 v17, v53, v29, v17
    v_dot2_f32_bf16 v18, v57, v29, v18
    v_dot2_f32_bf16 v19, v61, v29, v19
    v_dot2_f32_bf16 v12, v34, v30, v12
    v_dot2_f32_bf16 v13, v38, v30, v13
    v_dot2_f32_bf16 v14, v42, v30, v14
    v_dot2_f32_bf16 v15, v46, v30, v15
    v_dot2_f32_bf16 v16, v50, v30, v16
    v_dot2_f32_bf16 v17, v54, v30, v17
    v_dot2_f32_bf16 v18, v58, v30, v18
    v_dot2_f32_bf16 v19, v62, v30, v19
    v_dot2_f32_bf16 v12, v35, v31, v12
    v_dot2_f32_bf16 v13, v39, v31, v13
    v_dot2_f32_bf16 v14, v43, v31, v14
    v_dot2_f32_bf16 v15, v47, v31, v15
    v_dot2_f32_bf16 v16, v51, v31, v16
    v_dot2_f32_bf16 v17, v55, v31, v17
    v_dot2_f32_bf16 v18, v59, v31, v18
    v_dot2_f32_bf16 v19, v63, v31, v19
    s_nop 3
    v_add_f32_dpp v12, v12, v12 row_ror:8 row_mask:0xf bank_mask:0x3
    v_add_f32_dpp v12, v16, v16 row_ror:8 row_mask:0xf bank_mask:0xc
    v_add_f32_dpp v13, v13, v13 row_ror:8 row_mask:0xf bank_mask:0x3
    v_add_f32_dpp v13, v17, v17 row_ror:8 row_mask:0xf bank_mask:0xc
    v_add_f32_dpp v14, v14, v14 row_ror:8 row_mask:0xf bank_mask:0x3
    v_add_f32_dpp v14, v18, v18 row_ror:8 row_mask:0xf bank_mask:0xc
    v_add_f32_dpp v15, v15, v15 row_ror:8 row_mask:0xf bank_mask:0x3
    v_add_f32_dpp v15, v19, v19 row_ror:8 row_mask:0xf bank_mask:0xc
    s_nop 1
    v_add_f32_dpp v12, v12, v12 row_shl:4 row_mask:0xf bank_mask:0x5
    v_add_f32_dpp v12, v14, v14 row_shr:4 row_mask:0xf bank_mask:0xa
    v_add_f32_dpp v13, v13, v13 row_shl:4 row_mask:0xf bank_mask:0x5
    v_add_f32_dpp v13, v15, v15 row_shr:4 row_mask:0xf bank_mask:0xa
    s_nop 1
    v_add_f32_dpp v16, v12, v12 quad_perm:[2,3,0,1] row_mask:0xf bank_mask:0xf
    v_add_f32_dpp v17, v13, v13 quad_perm:[2,3,0,1] row_mask:0xf bank_mask:0xf
    s_nop 0
    v_cndmask_b32 v12, v16, v17, s[54:55]
    s_nop 1
    v_add_f32_dpp v12, v12, v12 quad_perm:[1,0,3,2] row_mask:0xf bank_mask:0xf
    v_cvt_pk_bf16_f32 v12, v12, v12
    v_and_b32 v12, 0xffff0000, v12
    v_mul_f32 v12, 0x3db504f3, v12
    v_cvt_pk_bf16_f32 v12, v12, v12
    v_and_b32 v12, 0xffff0000, v12
    v_mul_f32 v5, 0x3fb8aa3b, v12
    s_and_b32 s3, s41, 3
    s_mul_i32 s45, s3, 40960
    s_lshr_b32 s3, s41, 2
    s_mul_i32 s3, s3, 3
    s_add_u32 s3, s3, 0
    s_lshl_b32 s46, s3, 8
    s_add_u32 s45, s45, s46
    s_cmp_lt_u32 s3, 5
    s_cselect_b32 s45, s45, 0x80000000
    v_mul_u32_u24 v9, 10240, v3
    v_lshl_add_u32 v9, v4, 4, v9
    v_add_u32 v9, s45, v9
    buffer_load_dwordx4 v[32:35], v9, s[16:19], s78 offen offset:0
    buffer_load_dwordx4 v[36:39], v9, s[16:19], s79 offen offset:0
    buffer_load_dwordx4 v[40:43], v9, s[16:19], s80 offen offset:0
    buffer_load_dwordx4 v[44:47], v9, s[16:19], s81 offen offset:0
    buffer_load_dwordx4 v[48:51], v9, s[16:19], s82 offen offset:0
    buffer_load_dwordx4 v[52:55], v9, s[16:19], s83 offen offset:0
    buffer_load_dwordx4 v[56:59], v9, s[16:19], s84 offen offset:0
    buffer_load_dwordx4 v[60:63], v9, s[16:19], s85 offen offset:0
    s_waitcnt vmcnt(48)
    v_dot2_f32_bf16 v12, v64, v28, 0
    v_dot2_f32_bf16 v13, v68, v28, 0
    v_dot2_f32_bf16 v14, v72, v28, 0
    v_dot2_f32_bf16 v15, v76, v28, 0
    v_dot2_f32_bf16 v16, v80, v28, 0
    v_dot2_f32_bf16 v17, v84, v28, 0
    v_dot2_f32_bf16 v18, v88, v28, 0
    v_dot2_f32_bf16 v19, v92, v28, 0
    v_dot2_f32_bf16 v12, v65, v29, v12
    v_dot2_f32_bf16 v13, v69, v29, v13
    v_dot2_f32_bf16 v14, v73, v29, v14
    v_dot2_f32_bf16 v15, v77, v29, v15
    v_dot2_f32_bf16 v16, v81, v29, v16
    v_dot2_f32_bf16 v17, v85, v29, v17
    v_dot2_f32_bf16 v18, v89, v29, v18
    v_dot2_f32_bf16 v19, v93, v29, v19
    v_dot2_f32_bf16 v12, v66, v30, v12
    v_dot2_f32_bf16 v13, v70, v30, v13
    v_dot2_f32_bf16 v14, v74, v30, v14
    v_dot2_f32_bf16 v15, v78, v30, v15
    v_dot2_f32_bf16 v16, v82, v30, v16
    v_dot2_f32_bf16 v17, v86, v30, v17
    v_dot2_f32_bf16 v18, v90, v30, v18
    v_dot2_f32_bf16 v19, v94, v30, v19
    v_dot2_f32_bf16 v12, v67, v31, v12
    v_dot2_f32_bf16 v13, v71, v31, v13
    v_dot2_f32_bf16 v14, v75, v31, v14
    v_dot2_f32_bf16 v15, v79, v31, v15
    v_dot2_f32_bf16 v16, v83, v31, v16
    v_dot2_f32_bf16 v17, v87, v31, v17
    v_dot2_f32_bf16 v18, v91, v31, v18
    v_dot2_f32_bf16 v19, v95, v31, v19
    s_nop 3
    v_add_f32_dpp v12, v12, v12 row_ror:8 row_mask:0xf bank_mask:0x3
    v_add_f32_dpp v12, v16, v16 row_ror:8 row_mask:0xf bank_mask:0xc
    v_add_f32_dpp v13, v13, v13 row_ror:8 row_mask:0xf bank_mask:0x3
    v_add_f32_dpp v13, v17, v17 row_ror:8 row_mask:0xf bank_mask:0xc
    v_add_f32_dpp v14, v14, v14 row_ror:8 row_mask:0xf bank_mask:0x3
    v_add_f32_dpp v14, v18, v18 row_ror:8 row_mask:0xf bank_mask:0xc
    v_add_f32_dpp v15, v15, v15 row_ror:8 row_mask:0xf bank_mask:0x3
    v_add_f32_dpp v15, v19, v19 row_ror:8 row_mask:0xf bank_mask:0xc
    s_nop 1
    v_add_f32_dpp v12, v12, v12 row_shl:4 row_mask:0xf bank_mask:0x5
    v_add_f32_dpp v12, v14, v14 row_shr:4 row_mask:0xf bank_mask:0xa
    v_add_f32_dpp v13, v13, v13 row_shl:4 row_mask:0xf bank_mask:0x5
    v_add_f32_dpp v13, v15, v15 row_shr:4 row_mask:0xf bank_mask:0xa
    s_nop 1
    v_add_f32_dpp v16, v12, v12 quad_perm:[2,3,0,1] row_mask:0xf bank_mask:0xf
    v_add_f32_dpp v17, v13, v13 quad_perm:[2,3,0,1] row_mask:0xf bank_mask:0xf
    s_nop 0
    v_cndmask_b32 v12, v16, v17, s[54:55]
    s_nop 1
    v_add_f32_dpp v12, v12, v12 quad_perm:[1,0,3,2] row_mask:0xf bank_mask:0xf
    v_cvt_pk_bf16_f32 v12, v12, v12
    v_and_b32 v12, 0xffff0000, v12
    v_mul_f32 v12, 0x3db504f3, v12
    v_cvt_pk_bf16_f32 v12, v12, v12
    v_and_b32 v12, 0xffff0000, v12
    v_mul_f32 v6, 0x3fb8aa3b, v12
    s_and_b32 s3, s41, 3
    s_mul_i32 s45, s3, 40960
    s_lshr_b32 s3, s41, 2
    s_mul_i32 s3, s3, 3
    s_add_u32 s3, s3, 1
    s_lshl_b32 s46, s3, 8
    s_add_u32 s45, s45, s46
    s_cmp_lt_u32 s3, 5
    s_cselect_b32 s45, s45, 0x80000000
    v_mul_u32_u24 v9, 10240, v3
    v_lshl_add_u32 v9, v4, 4, v9
    v_add_u32 v9, s45, v9
    buffer_load_dwordx4 v[64:67], v9, s[16:19], s78 offen offset:0
    buffer_load_dwordx4 v[68:71], v9, s[16:19], s79 offen offset:0
    buffer_load_dwordx4 v[72:75], v9, s[16:19], s80 offen offset:0
    buffer_load_dwordx4 v[76:79], v9, s[16:19], s81 offen offset:0
    buffer_load_dwordx4 v[80:83], v9, s[16:19], s82 offen offset:0
    buffer_load_dwordx4 v[84:87], v9, s[16:19], s83 offen offset:0
    buffer_load_dwordx4 v[88:91], v9, s[16:19], s84 offen offset:0
    buffer_load_dwordx4 v[92:95], v9, s[16:19], s85 offen offset:0
    s_waitcnt vmcnt(48)
    v_dot2_f32_bf16 v12, v96, v28, 0
    v_dot2_f32_bf16 v13, v100, v28, 0
    v_dot2_f32_bf16 v14, v104, v28, 0
    v_dot2_f32_bf16 v15, v108, v28, 0
    v_dot2_f32_bf16 v16, v112, v28, 0
    v_dot2_f32_bf16 v17, v116, v28, 0
    v_dot2_f32_bf16 v18, v120, v28, 0
    v_dot2_f32_bf16 v19, v124, v28, 0
    v_dot2_f32_bf16 v12, v97, v29, v12
    v_dot2_f32_bf16 v13, v101, v29, v13
    v_dot2_f32_bf16 v14, v105, v29, v14
    v_dot2_f32_bf16 v15, v109, v29, v15
    v_dot2_f32_bf16 v16, v113, v29, v16
    v_dot2_f32_bf16 v17, v117, v29, v17
    v_dot2_f32_bf16 v18, v121, v29, v18
    v_dot2_f32_bf16 v19, v125, v29, v19
    v_dot2_f32_bf16 v12, v98, v30, v12
    v_dot2_f32_bf16 v13, v102, v30, v13
    v_dot2_f32_bf16 v14, v106, v30, v14
    v_dot2_f32_bf16 v15, v110, v30, v15
    v_dot2_f32_bf16 v16, v114, v30, v16
    v_dot2_f32_bf16 v17, v118, v30, v17
    v_dot2_f32_bf16 v18, v122, v30, v18
    v_dot2_f32_bf16 v19, v126, v30, v19
    v_dot2_f32_bf16 v12, v99, v31, v12
    v_dot2_f32_bf16 v13, v103, v31, v13
    v_dot2_f32_bf16 v14, v107, v31, v14
    v_dot2_f32_bf16 v15, v111, v31, v15
    v_dot2_f32_bf16 v16, v115, v31, v16
    v_dot2_f32_bf16 v17, v119, v31, v17
    v_dot2_f32_bf16 v18, v123, v31, v18
    v_dot2_f32_bf16 v19, v127, v31, v19
    s_nop 3
    v_add_f32_dpp v12, v12, v12 row_ror:8 row_mask:0xf bank_mask:0x3
    v_add_f32_dpp v12, v16, v16 row_ror:8 row_mask:0xf bank_mask:0xc
    v_add_f32_dpp v13, v13, v13 row_ror:8 row_mask:0xf bank_mask:0x3
    v_add_f32_dpp v13, v17, v17 row_ror:8 row_mask:0xf bank_mask:0xc
    v_add_f32_dpp v14, v14, v14 row_ror:8 row_mask:0xf bank_mask:0x3
    v_add_f32_dpp v14, v18, v18 row_ror:8 row_mask:0xf bank_mask:0xc
    v_add_f32_dpp v15, v15, v15 row_ror:8 row_mask:0xf bank_mask:0x3
    v_add_f32_dpp v15, v19, v19 row_ror:8 row_mask:0xf bank_mask:0xc
    s_nop 1
    v_add_f32_dpp v12, v12, v12 row_shl:4 row_mask:0xf bank_mask:0x5
    v_add_f32_dpp v12, v14, v14 row_shr:4 row_mask:0xf bank_mask:0xa
    v_add_f32_dpp v13, v13, v13 row_shl:4 row_mask:0xf bank_mask:0x5
    v_add_f32_dpp v13, v15, v15 row_shr:4 row_mask:0xf bank_mask:0xa
    s_nop 1
    v_add_f32_dpp v16, v12, v12 quad_perm:[2,3,0,1] row_mask:0xf bank_mask:0xf
    v_add_f32_dpp v17, v13, v13 quad_perm:[2,3,0,1] row_mask:0xf bank_mask:0xf
    s_nop 0
    v_cndmask_b32 v12, v16, v17, s[54:55]
    s_nop 1
    v_add_f32_dpp v12, v12, v12 quad_perm:[1,0,3,2] row_mask:0xf bank_mask:0xf
    v_cvt_pk_bf16_f32 v12, v12, v12
    v_and_b32 v12, 0xffff0000, v12
    v_mul_f32 v12, 0x3db504f3, v12
    v_cvt_pk_bf16_f32 v12, v12, v12
    v_and_b32 v12, 0xffff0000, v12
    v_mul_f32 v7, 0x3fb8aa3b, v12
    buffer_load_dwordx4 v[96:99], v2, s[8:11], s66 offen offset:0 nt
    buffer_load_dwordx4 v[100:103], v2, s[8:11], s66 offen offset:1024 nt
    buffer_load_dwordx4 v[104:107], v2, s[8:11], s66 offen offset:2048 nt
    buffer_load_dwordx4 v[108:111], v2, s[8:11], s66 offen offset:3072 nt
    buffer_load_dwordx4 v[112:115], v2, s[8:11], s67 offen offset:0 nt
    buffer_load_dwordx4 v[116:119], v2, s[8:11], s67 offen offset:1024 nt
    buffer_load_dwordx4 v[120:123], v2, s[8:11], s67 offen offset:2048 nt
    buffer_load_dwordx4 v[124:127], v2, s[8:11], s67 offen offset:3072 nt
    s_waitcnt vmcnt(48)
    v_dot2_f32_bf16 v12, v224, v28, 0
    v_dot2_f32_bf16 v13, v228, v28, 0
    v_dot2_f32_bf16 v14, v232, v28, 0
    v_dot2_f32_bf16 v15, v236, v28, 0
    v_dot2_f32_bf16 v16, v240, v28, 0
    v_dot2_f32_bf16 v17, v244, v28, 0
    v_dot2_f32_bf16 v18, v248, v28, 0
    v_dot2_f32_bf16 v19, v252, v28, 0
    v_dot2_f32_bf16 v12, v225, v29, v12
    v_dot2_f32_bf16 v13, v229, v29, v13
    v_dot2_f32_bf16 v14, v233, v29, v14
    v_dot2_f32_bf16 v15, v237, v29, v15
    v_dot2_f32_bf16 v16, v241, v29, v16
    v_dot2_f32_bf16 v17, v245, v29, v17
    v_dot2_f32_bf16 v18, v249, v29, v18
    v_dot2_f32_bf16 v19, v253, v29, v19
    v_dot2_f32_bf16 v12, v226, v30, v12
    v_dot2_f32_bf16 v13, v230, v30, v13
    v_dot2_f32_bf16 v14, v234, v30, v14
    v_dot2_f32_bf16 v15, v238, v30, v15
    v_dot2_f32_bf16 v16, v242, v30, v16
    v_dot2_f32_bf16 v17, v246, v30, v17
    v_dot2_f32_bf16 v18, v250, v30, v18
    v_dot2_f32_bf16 v19, v254, v30, v19
    v_dot2_f32_bf16 v12, v227, v31, v12
    v_dot2_f32_bf16 v13, v231, v31, v13
    v_dot2_f32_bf16 v14, v235, v31, v14
    v_dot2_f32_bf16 v15, v239, v31, v15
    v_dot2_f32_bf16 v16, v243, v31, v16
    v_dot2_f32_bf16 v17, v247, v31, v17
    v_dot2_f32_bf16 v18, v251, v31, v18
    v_dot2_f32_bf16 v19, v255, v31, v19
    s_nop 3
    v_add_f32_dpp v12, v12, v12 row_ror:8 row_mask:0xf bank_mask:0x3
    v_add_f32_dpp v12, v16, v16 row_ror:8 row_mask:0xf bank_mask:0xc
    v_add_f32_dpp v13, v13, v13 row_ror:8 row_mask:0xf bank_mask:0x3
    v_add_f32_dpp v13, v17, v17 row_ror:8 row_mask:0xf bank_mask:0xc
    v_add_f32_dpp v14, v14, v14 row_ror:8 row_mask:0xf bank_mask:0x3
    v_add_f32_dpp v14, v18, v18 row_ror:8 row_mask:0xf bank_mask:0xc
    v_add_f32_dpp v15, v15, v15 row_ror:8 row_mask:0xf bank_mask:0x3
    v_add_f32_dpp v15, v19, v19 row_ror:8 row_mask:0xf bank_mask:0xc
    s_nop 1
    v_add_f32_dpp v12, v12, v12 row_shl:4 row_mask:0xf bank_mask:0x5
    v_add_f32_dpp v12, v14, v14 row_shr:4 row_mask:0xf bank_mask:0xa
    v_add_f32_dpp v13, v13, v13 row_shl:4 row_mask:0xf bank_mask:0x5
    v_add_f32_dpp v13, v15, v15 row_shr:4 row_mask:0xf bank_mask:0xa
    s_nop 1
    v_add_f32_dpp v16, v12, v12 quad_perm:[2,3,0,1] row_mask:0xf bank_mask:0xf
    v_add_f32_dpp v17, v13, v13 quad_perm:[2,3,0,1] row_mask:0xf bank_mask:0xf
    s_nop 0
    v_cndmask_b32 v12, v16, v17, s[54:55]
    s_nop 1
    v_add_f32_dpp v12, v12, v12 quad_perm:[1,0,3,2] row_mask:0xf bank_mask:0xf
    v_cvt_pk_bf16_f32 v12, v12, v12
    v_and_b32 v12, 0xffff0000, v12
    v_mul_f32 v12, 0x3db504f3, v12
    v_cvt_pk_bf16_f32 v12, v12, v12
    v_and_b32 v12, 0xffff0000, v12
    v_mul_f32 v8, 0x3fb8aa3b, v12
    v_max_f32 v9, v5, v6
    v_max3_f32 v9, v9, v7, v8
    s_nop 1
    v_max_f32_dpp v9, v9, v9 row_ror:8 row_mask:0xf bank_mask:0xf
    s_nop 1
    v_max_f32_dpp v9, v9, v9 row_ror:4 row_mask:0xf bank_mask:0xf
    s_nop 1
    v_max_f32_dpp v9, v9, v9 row_ror:2 row_mask:0xf bank_mask:0xf
    s_nop 1
    v_max_f32_dpp v9, v9, v9 row_ror:1 row_mask:0xf bank_mask:0xf
    s_nop 1
    v_max_f32_dpp v9, v9, v9 row_bcast:15 row_mask:0xa bank_mask:0xf
    s_nop 1
    v_max_f32_dpp v9, v9, v9 row_bcast:31 row_mask:0xc bank_mask:0xf
    s_nop 1
    v_readlane_b32 s50, v9, 63
    s_nop 1
    v_subrev_f32 v5, s50, v5
    v_subrev_f32 v6, s50, v6
    v_subrev_f32 v7, s50, v7
    v_subrev_f32 v8, s50, v8
    v_exp_f32 v5, v5
    v_exp_f32 v6, v6
    v_exp_f32 v7, v7
    v_exp_f32 v8, v8
    s_nop 0
    v_add_f32 v9, v5, v6
    v_add_f32 v10, v7, v8
    v_add_f32 v9, v9, v10
    v_lshrrev_b32 v10, 1, v4
    v_lshlrev_b32 v10, 1, v10
    v_lshl_add_u32 v10, v3, 4, v10
    s_lshl_b32 s3, s41, 8
    v_add_u32 v10, s3, v10
    v_cvt_pk_bf16_f32 v5, v5, v5
    ds_write_b16 v10, v5 offset:6912
    v_cvt_pk_bf16_f32 v6, v6, v6
    ds_write_b16 v10, v6 offset:6976
    v_cvt_pk_bf16_f32 v7, v7, v7
    ds_write_b16 v10, v7 offset:7040
    v_cvt_pk_bf16_f32 v8, v8, v8
    ds_write_b16 v10, v8 offset:7104
    s_nop 1
    v_add_f32_dpp v9, v9, v9 row_ror:8 row_mask:0xf bank_mask:0xf
    s_nop 1
    v_add_f32_dpp v9, v9, v9 row_ror:4 row_mask:0xf bank_mask:0xf
    s_nop 1
    v_add_f32_dpp v9, v9, v9 row_ror:2 row_mask:0xf bank_mask:0xf
    s_nop 1
    v_add_f32_dpp v9, v9, v9 row_ror:1 row_mask:0xf bank_mask:0xf
    s_nop 1
    v_add_f32_dpp v9, v9, v9 row_bcast:15 row_mask:0xa bank_mask:0xf
    s_nop 1
    v_add_f32_dpp v9, v9, v9 row_bcast:31 row_mask:0xc bank_mask:0xf
    s_nop 1
    v_readlane_b32 s51, v9, 63
    s_nop 1
    v_mov_b32 v12, s50
    v_mov_b32 v13, s51
    v_mul_f32 v13, 0.5, v13
    s_lshl_b32 s3, s41, 3
    v_mov_b32 v9, s3
    s_mov_b64 exec, 1
    ds_write_b64 v9, v[12:13] offset:8960
    s_mov_b64 exec, -1
    v_lshlrev_b32 v31, 4, v3
    s_lshl_b32 s3, s41, 8
    v_add_u32 v31, s3, v31
    s_waitcnt lgkmcnt(0)
    ds_read_b128 v[24:27], v31 offset:6912
    s_waitcnt vmcnt(40)
    s_waitcnt lgkmcnt(0)
    v_perm_b32 v12, v132, v128, s43
    v_perm_b32 v13, v140, v136, s43
    v_perm_b32 v14, v148, v144, s43
    v_perm_b32 v15, v156, v152, s43
    v_perm_b32 v16, v132, v128, s44
    v_perm_b32 v17, v140, v136, s44
    v_perm_b32 v18, v148, v144, s44
    v_perm_b32 v19, v156, v152, s44
    v_mfma_f32_16x16x32_bf16 v[224:227], v[24:27], v[12:15], 0
    v_perm_b32 v20, v133, v129, s43
    v_perm_b32 v21, v141, v137, s43
    v_perm_b32 v22, v149, v145, s43
    v_perm_b32 v23, v157, v153, s43
    v_mfma_f32_16x16x32_bf16 v[228:231], v[24:27], v[16:19], 0
    v_perm_b32 v12, v133, v129, s44
    v_perm_b32 v13, v141, v137, s44
    v_perm_b32 v14, v149, v145, s44
    v_perm_b32 v15, v157, v153, s44
    v_mfma_f32_16x16x32_bf16 v[232:235], v[24:27], v[20:23], 0
    v_perm_b32 v16, v134, v130, s43
    v_perm_b32 v17, v142, v138, s43
    v_perm_b32 v18, v150, v146, s43
    v_perm_b32 v19, v158, v154, s43
    v_mfma_f32_16x16x32_bf16 v[236:239], v[24:27], v[12:15], 0
    v_perm_b32 v20, v134, v130, s44
    v_perm_b32 v21, v142, v138, s44
    v_perm_b32 v22, v150, v146, s44
    v_perm_b32 v23, v158, v154, s44
    v_mfma_f32_16x16x32_bf16 v[240:243], v[24:27], v[16:19], 0
    v_perm_b32 v12, v135, v131, s43
    v_perm_b32 v13, v143, v139, s43
    v_perm_b32 v14, v151, v147, s43
    v_perm_b32 v15, v159, v155, s43
    v_mfma_f32_16x16x32_bf16 v[244:247], v[24:27], v[20:23], 0
    v_perm_b32 v16, v135, v131, s44
    v_perm_b32 v17, v143, v139, s44
    v_perm_b32 v18, v151, v147, s44
    v_perm_b32 v19, v159, v155, s44
    v_mfma_f32_16x16x32_bf16 v[248:251], v[24:27], v[12:15], 0
    s_nop 1
    v_mfma_f32_16x16x32_bf16 v[252:255], v[24:27], v[16:19], 0
    s_and_b32 s3, s41, 3
    s_mul_i32 s45, s3, 40960
    s_lshr_b32 s3, s41, 2
    s_mul_i32 s3, s3, 3
    s_add_u32 s3, s3, 2
    s_lshl_b32 s46, s3, 8
    s_add_u32 s45, s45, s46
    s_cmp_lt_u32 s3, 5
    s_cselect_b32 s45, s45, 0x80000000
    v_mul_u32_u24 v9, 10240, v3
    v_lshl_add_u32 v9, v4, 4, v9
    v_add_u32 v9, s45, v9
    buffer_load_dwordx4 v[128:131], v9, s[16:19], s78 offen offset:0
    buffer_load_dwordx4 v[132:135], v9, s[16:19], s79 offen offset:0
    buffer_load_dwordx4 v[136:139], v9, s[16:19], s80 offen offset:0
    buffer_load_dwordx4 v[140:143], v9, s[16:19], s81 offen offset:0
    buffer_load_dwordx4 v[144:147], v9, s[16:19], s82 offen offset:0
    buffer_load_dwordx4 v[148:151], v9, s[16:19], s83 offen offset:0
    buffer_load_dwordx4 v[152:155], v9, s[16:19], s84 offen offset:0
    buffer_load_dwordx4 v[156:159], v9, s[16:19], s85 offen offset:0
    v_mov_b32 v9, 0
    global_load_dword v30, v9, s[36:37] sc1
    ds_read_b128 v[24:27], v31 offset:6976
    s_waitcnt vmcnt(41)
    s_waitcnt lgkmcnt(0)
    v_perm_b32 v12, v164, v160, s43
    v_perm_b32 v13, v172, v168, s43
    v_perm_b32 v14, v180, v176, s43
    v_perm_b32 v15, v188, v184, s43
    v_perm_b32 v16, v164, v160, s44
    v_perm_b32 v17, v172, v168, s44
    v_perm_b32 v18, v180, v176, s44
    v_perm_b32 v19, v188, v184, s44
    v_mfma_f32_16x16x32_bf16 v[224:227], v[24:27], v[12:15], v[224:227]
    v_perm_b32 v20, v165, v161, s43
    v_perm_b32 v21, v173, v169, s43
    v_perm_b32 v22, v181, v177, s43
    v_perm_b32 v23, v189, v185, s43
    v_mfma_f32_16x16x32_bf16 v[228:231], v[24:27], v[16:19], v[228:231]
    v_perm_b32 v12, v165, v161, s44
    v_perm_b32 v13, v173, v169, s44
    v_perm_b32 v14, v181, v177, s44
    v_perm_b32 v15, v189, v185, s44
    v_mfma_f32_16x16x32_bf16 v[232:235], v[24:27], v[20:23], v[232:235]
    v_perm_b32 v16, v166, v162, s43
    v_perm_b32 v17, v174, v170, s43
    v_perm_b32 v18, v182, v178, s43
    v_perm_b32 v19, v190, v186, s43
    v_mfma_f32_16x16x32_bf16 v[236:239], v[24:27], v[12:15], v[236:239]
    v_perm_b32 v20, v166, v162, s44
    v_perm_b32 v21, v174, v170, s44
    v_perm_b32 v22, v182, v178, s44
    v_perm_b32 v23, v190, v186, s44
    v_mfma_f32_16x16x32_bf16 v[240:243], v[24:27], v[16:19], v[240:243]
    v_perm_b32 v12, v167, v163, s43
    v_perm_b32 v13, v175, v171, s43
    v_perm_b32 v14, v183, v179, s43
    v_perm_b32 v15, v191, v187, s43
    v_mfma_f32_16x16x32_bf16 v[244:247], v[24:27], v[20:23], v[244:247]
    v_perm_b32 v16, v167, v163, s44
    v_perm_b32 v17, v175, v171, s44
    v_perm_b32 v18, v183, v179, s44
    v_perm_b32 v19, v191, v187, s44
    v_mfma_f32_16x16x32_bf16 v[248:251], v[24:27], v[12:15], v[248:251]
    s_nop 1
    v_mfma_f32_16x16x32_bf16 v[252:255], v[24:27], v[16:19], v[252:255]
    ds_read_b128 v[24:27], v31 offset:7040
    s_waitcnt vmcnt(33)
    s_waitcnt lgkmcnt(0)
    v_perm_b32 v12, v196, v192, s43
    v_perm_b32 v13, v204, v200, s43
    v_perm_b32 v14, v212, v208, s43
    v_perm_b32 v15, v220, v216, s43
    v_perm_b32 v16, v196, v192, s44
    v_perm_b32 v17, v204, v200, s44
    v_perm_b32 v18, v212, v208, s44
    v_perm_b32 v19, v220, v216, s44
    v_mfma_f32_16x16x32_bf16 v[224:227], v[24:27], v[12:15], v[224:227]
    v_perm_b32 v20, v197, v193, s43
    v_perm_b32 v21, v205, v201, s43
    v_perm_b32 v22, v213, v209, s43
    v_perm_b32 v23, v221, v217, s43
    v_mfma_f32_16x16x32_bf16 v[228:231], v[24:27], v[16:19], v[228:231]
    v_perm_b32 v12, v197, v193, s44
    v_perm_b32 v13, v205, v201, s44
    v_perm_b32 v14, v213, v209, s44
    v_perm_b32 v15, v221, v217, s44
    v_mfma_f32_16x16x32_bf16 v[232:235], v[24:27], v[20:23], v[232:235]
    v_perm_b32 v16, v198, v194, s43
    v_perm_b32 v17, v206, v202, s43
    v_perm_b32 v18, v214, v210, s43
    v_perm_b32 v19, v222, v218, s43
    v_mfma_f32_16x16x32_bf16 v[236:239], v[24:27], v[12:15], v[236:239]
    v_perm_b32 v20, v198, v194, s44
    v_perm_b32 v21, v206, v202, s44
    v_perm_b32 v22, v214, v210, s44
    v_perm_b32 v23, v222, v218, s44
    v_mfma_f32_16x16x32_bf16 v[240:243], v[24:27], v[16:19], v[240:243]
    v_perm_b32 v12, v199, v195, s43
    v_perm_b32 v13, v207, v203, s43
    v_perm_b32 v14, v215, v211, s43
    v_perm_b32 v15, v223, v219, s43
    v_mfma_f32_16x16x32_bf16 v[244:247], v[24:27], v[20:23], v[244:247]
    v_perm_b32 v16, v199, v195, s44
    v_perm_b32 v17, v207, v203, s44
    v_perm_b32 v18, v215, v211, s44
    v_perm_b32 v19, v223, v219, s44
    v_mfma_f32_16x16x32_bf16 v[248:251], v[24:27], v[12:15], v[248:251]
    s_nop 1
    v_mfma_f32_16x16x32_bf16 v[252:255], v[24:27], v[16:19], v[252:255]
    s_waitcnt vmcnt(17)
    v_perm_b32 v160, v36, v32, s43
    v_perm_b32 v161, v44, v40, s43
    v_perm_b32 v162, v52, v48, s43
    v_perm_b32 v163, v60, v56, s43
    v_perm_b32 v164, v36, v32, s44
    v_perm_b32 v165, v44, v40, s44
    v_perm_b32 v166, v52, v48, s44
    v_perm_b32 v167, v60, v56, s44
    v_perm_b32 v168, v37, v33, s43
    v_perm_b32 v169, v45, v41, s43
    v_perm_b32 v170, v53, v49, s43
    v_perm_b32 v171, v61, v57, s43
    v_perm_b32 v172, v37, v33, s44
    v_perm_b32 v173, v45, v41, s44
    v_perm_b32 v174, v53, v49, s44
    v_perm_b32 v175, v61, v57, s44
    v_perm_b32 v176, v38, v34, s43
    v_perm_b32 v177, v46, v42, s43
    v_perm_b32 v178, v54, v50, s43
    v_perm_b32 v179, v62, v58, s43
    v_perm_b32 v180, v38, v34, s44
    v_perm_b32 v181, v46, v42, s44
    v_perm_b32 v182, v54, v50, s44
    v_perm_b32 v183, v62, v58, s44
    v_perm_b32 v184, v39, v35, s43
    v_perm_b32 v185, v47, v43, s43
    v_perm_b32 v186, v55, v51, s43
    v_perm_b32 v187, v63, v59, s43
    v_perm_b32 v188, v39, v35, s44
    v_perm_b32 v189, v47, v43, s44
    v_perm_b32 v190, v55, v51, s44
    v_perm_b32 v191, v63, v59, s44
    v_perm_b32 v192, v68, v64, s43
    v_perm_b32 v193, v76, v72, s43
    v_perm_b32 v194, v84, v80, s43
    v_perm_b32 v195, v92, v88, s43
    v_perm_b32 v196, v68, v64, s44
    v_perm_b32 v197, v76, v72, s44
    v_perm_b32 v198, v84, v80, s44
    v_perm_b32 v199, v92, v88, s44
    v_perm_b32 v200, v69, v65, s43
    v_perm_b32 v201, v77, v73, s43
    v_perm_b32 v202, v85, v81, s43
    v_perm_b32 v203, v93, v89, s43
    v_perm_b32 v204, v69, v65, s44
    v_perm_b32 v205, v77, v73, s44
    v_perm_b32 v206, v85, v81, s44
    v_perm_b32 v207, v93, v89, s44
    v_perm_b32 v208, v70, v66, s43
    v_perm_b32 v209, v78, v74, s43
    v_perm_b32 v210, v86, v82, s43
    v_perm_b32 v211, v94, v90, s43
    v_perm_b32 v212, v70, v66, s44
    v_perm_b32 v213, v78, v74, s44
    v_perm_b32 v214, v86, v82, s44
    v_perm_b32 v215, v94, v90, s44
    v_perm_b32 v216, v71, v67, s43
    v_perm_b32 v217, v79, v75, s43
    v_perm_b32 v218, v87, v83, s43
    v_perm_b32 v219, v95, v91, s43
    v_perm_b32 v220, v71, v67, s44
    v_perm_b32 v221, v79, v75, s44
    v_perm_b32 v222, v87, v83, s44
    v_perm_b32 v223, v95, v91, s44
    s_sub_u32 s48, s2, 80
    s_cmp_lt_u32 s48, 54
    s_cselect_b32 s46, 5, 0
    s_cmp_lt_u32 s41, s46
    s_cselect_b32 s46, 0, 0x80000000
    v_lshrrev_b32 v9, 2, v4
    v_lshlrev_b32 v9, 2, v9
    v_add_u32 v9, v9, v3
    v_mul_u32_u24 v9, 27648, v9
    v_and_b32 v10, 3, v4
    v_lshl_add_u32 v9, v10, 4, v9
    s_mul_i32 s45, s41, 442368
    s_lshl_b32 s3, s48, 6
    s_add_u32 s45, s45, s3
    s_cmp_eq_u32 s46, 0
    s_cselect_b32 s45, s45, s46
    v_add_u32 v9, s45, v9
    buffer_load_dwordx4 v[32:35], v9, s[20:23], s86 offen offset:0
    buffer_load_dwordx4 v[36:39], v9, s[20:23], s87 offen offset:0
    buffer_load_dwordx4 v[40:43], v9, s[20:23], s88 offen offset:0
    buffer_load_dwordx4 v[44:47], v9, s[20:23], s89 offen offset:0
    buffer_load_dwordx4 v[48:51], v9, s[20:23], s90 offen offset:0
    buffer_load_dwordx4 v[52:55], v9, s[20:23], s91 offen offset:0
    buffer_load_dwordx4 v[56:59], v9, s[20:23], s92 offen offset:0
    buffer_load_dwordx4 v[60:63], v9, s[20:23], s93 offen offset:0
    s_sub_u32 s48, s2, 80
    s_cmp_lt_u32 s48, 54
    s_cselect_b32 s46, 5, 0
    s_cmp_lt_u32 s41, s46
    s_cselect_b32 s46, 0, 0x80000000
    v_mul_u32_u24 v9, 10240, v3
    v_lshl_add_u32 v9, v4, 4, v9
    s_mul_i32 s45, s48, 40960
    s_lshl_b32 s3, s41, 8
    s_add_u32 s45, s45, s3
    s_cmp_eq_u32 s46, 0
    s_cselect_b32 s45, s45, s46
    v_add_u32 v9, s45, v9
    buffer_load_dwordx4 v[64:67], v9, s[24:27], s78 offen offset:0
    buffer_load_dwordx4 v[68:71], v9, s[24:27], s79 offen offset:0
    buffer_load_dwordx4 v[72:75], v9, s[24:27], s80 offen offset:0
    buffer_load_dwordx4 v[76:79], v9, s[24:27], s81 offen offset:0
    buffer_load_dwordx4 v[80:83], v9, s[24:27], s82 offen offset:0
    buffer_load_dwordx4 v[84:87], v9, s[24:27], s83 offen offset:0
    buffer_load_dwordx4 v[88:91], v9, s[24:27], s84 offen offset:0
    buffer_load_dwordx4 v[92:95], v9, s[24:27], s85 offen offset:0
    ds_read_b128 v[24:27], v31 offset:7104
    s_waitcnt vmcnt(25)
    s_waitcnt lgkmcnt(0)
    v_perm_b32 v12, v100, v96, s43
    v_perm_b32 v13, v108, v104, s43
    v_perm_b32 v14, v116, v112, s43
    v_perm_b32 v15, v124, v120, s43
    v_perm_b32 v16, v100, v96, s44
    v_perm_b32 v17, v108, v104, s44
    v_perm_b32 v18, v116, v112, s44
    v_perm_b32 v19, v124, v120, s44
    v_mfma_f32_16x16x32_bf16 v[224:227], v[24:27], v[12:15], v[224:227]
    v_perm_b32 v20, v101, v97, s43
    v_perm_b32 v21, v109, v105, s43
    v_perm_b32 v22, v117, v113, s43
    v_perm_b32 v23, v125, v121, s43
    v_mfma_f32_16x16x32_bf16 v[228:231], v[24:27], v[16:19], v[228:231]
    v_perm_b32 v12, v101, v97, s44
    v_perm_b32 v13, v109, v105, s44
    v_perm_b32 v14, v117, v113, s44
    v_perm_b32 v15, v125, v121, s44
    v_mfma_f32_16x16x32_bf16 v[232:235], v[24:27], v[20:23], v[232:235]
    v_perm_b32 v16, v102, v98, s43
    v_perm_b32 v17, v110, v106, s43
    v_perm_b32 v18, v118, v114, s43
    v_perm_b32 v19, v126, v122, s43
    v_mfma_f32_16x16x32_bf16 v[236:239], v[24:27], v[12:15], v[236:239]
    v_perm_b32 v20, v102, v98, s44
    v_perm_b32 v21, v110, v106, s44
    v_perm_b32 v22, v118, v114, s44
    v_perm_b32 v23, v126, v122, s44
    v_mfma_f32_16x16x32_bf16 v[240:243], v[24:27], v[16:19], v[240:243]
    v_perm_b32 v12, v103, v99, s43
    v_perm_b32 v13, v111, v107, s43
    v_perm_b32 v14, v119, v115, s43
    v_perm_b32 v15, v127, v123, s43
    v_mfma_f32_16x16x32_bf16 v[244:247], v[24:27], v[20:23], v[244:247]
    v_perm_b32 v16, v103, v99, s44
    v_perm_b32 v17, v111, v107, s44
    v_perm_b32 v18, v119, v115, s44
    v_perm_b32 v19, v127, v123, s44
    v_mfma_f32_16x16x32_bf16 v[248:251], v[24:27], v[12:15], v[248:251]
    s_nop 1
    v_mfma_f32_16x16x32_bf16 v[252:255], v[24:27], v[16:19], v[252:255]
    s_lshl_b32 s3, s41, 9
    v_lshlrev_b32 v10, 5, v4
    v_add_u32 v10, s3, v10
    v_add_u32 v10, 2560, v10
    s_nop 7
    s_nop 1
    s_mov_b64 exec, 0xffff
    ds_write2_b32 v10, v224, v228 offset0:0 offset1:1
    ds_write2_b32 v10, v232, v236 offset0:2 offset1:3
    ds_write2_b32 v10, v240, v244 offset0:4 offset1:5
    ds_write2_b32 v10, v248, v252 offset0:6 offset1:7
    s_mov_b64 exec, -1
    s_waitcnt vmcnt(17)
    v_perm_b32 v96, v132, v128, s43
    v_perm_b32 v97, v140, v136, s43
    v_perm_b32 v98, v148, v144, s43
    v_perm_b32 v99, v156, v152, s43
    v_perm_b32 v100, v132, v128, s44
    v_perm_b32 v101, v140, v136, s44
    v_perm_b32 v102, v148, v144, s44
    v_perm_b32 v103, v156, v152, s44
    v_perm_b32 v104, v133, v129, s43
    v_perm_b32 v105, v141, v137, s43
    v_perm_b32 v106, v149, v145, s43
    v_perm_b32 v107, v157, v153, s43
    v_perm_b32 v108, v133, v129, s44
    v_perm_b32 v109, v141, v137, s44
    v_perm_b32 v110, v149, v145, s44
    v_perm_b32 v111, v157, v153, s44
    v_perm_b32 v112, v134, v130, s43
    v_perm_b32 v113, v142, v138, s43
    v_perm_b32 v114, v150, v146, s43
    v_perm_b32 v115, v158, v154, s43
    v_perm_b32 v116, v134, v130, s44
    v_perm_b32 v117, v142, v138, s44
    v_perm_b32 v118, v150, v146, s44
    v_perm_b32 v119, v158, v154, s44
    v_perm_b32 v120, v135, v131, s43
    v_perm_b32 v121, v143, v139, s43
    v_perm_b32 v122, v151, v147, s43
    v_perm_b32 v123, v159, v155, s43
    v_perm_b32 v124, v135, v131, s44
    v_perm_b32 v125, v143, v139, s44
    v_perm_b32 v126, v151, v147, s44
    v_perm_b32 v127, v159, v155, s44
    s_waitcnt lgkmcnt(0)
    s_barrier
    v_mov_b32 v9, 0
    ds_read_b128 v[128:131], v9 offset:8960
    ds_read_b128 v[132:135], v9 offset:8976
    ds_read_b128 v[136:139], v9 offset:8992
    ds_read_b128 v[140:143], v9 offset:9008
    s_and_b32 s3, s41, 3
    s_lshl_b32 s3, s3, 5
    v_and_b32 v20, 31, v1
    v_add_u32 v20, s3, v20
    v_lshlrev_b32 v9, 2, v20
    ds_read_b32 v12, v9 offset:2560
    ds_read_b32 v13, v9 offset:3072
    ds_read_b32 v14, v9 offset:3584
    ds_read_b32 v15, v9 offset:4096
    ds_read_b32 v16, v9 offset:4608
    ds_read_b32 v17, v9 offset:5120
    ds_read_b32 v18, v9 offset:5632
    ds_read_b32 v19, v9 offset:6144
    s_waitcnt lgkmcnt(8)
    v_max3_f32 v10, v128, v130, v132
    v_max3_f32 v11, v134, v136, v138
    v_max3_f32 v10, v10, v140, v142
    v_max_f32 v10, v10, v11
    v_sub_f32 v128, v128, v10
    v_sub_f32 v130, v130, v10
    v_sub_f32 v132, v132, v10
    v_sub_f32 v134, v134, v10
    v_sub_f32 v136, v136, v10
    v_sub_f32 v138, v138, v10
    v_sub_f32 v140, v140, v10
    v_sub_f32 v142, v142, v10
    v_exp_f32 v128, v128
    v_exp_f32 v130, v130
    v_exp_f32 v132, v132
    v_exp_f32 v134, v134
    v_exp_f32 v136, v136
    v_exp_f32 v138, v138
    v_exp_f32 v140, v140
    v_exp_f32 v142, v142
    s_nop 0
    v_mul_f32 v11, v128, v129
    v_mul_f32 v21, v130, v131
    v_fmac_f32 v11, v132, v133
    v_fmac_f32 v21, v134, v135
    v_fmac_f32 v11, v136, v137
    v_fmac_f32 v21, v138, v139
    v_fmac_f32 v11, v140, v141
    v_fmac_f32 v21, v142, v143
    v_add_f32 v11, v11, v21
    s_waitcnt lgkmcnt(0)
    v_mul_f32 v12, v12, v128
    v_mul_f32 v13, v13, v130
    v_rcp_f32 v22, v11
    v_fmac_f32 v12, v14, v132
    v_fmac_f32 v13, v15, v134
    v_fmac_f32 v12, v16, v136
    v_fmac_f32 v13, v17, v138
    v_fmac_f32 v12, v18, v140
    v_fmac_f32 v13, v19, v142
    v_add_f32 v12, v12, v13
    v_mul_f32 v12, v12, v22
    v_cvt_pk_bf16_f32 v12, v12, v12
    v_lshlrev_b32 v9, 1, v20
    ds_write_b16 v9, v12 offset:6656
    s_cmp_lg_u32 s41, 0
    s_cbranch_scc1 L_noo
    v_or_b32 v14, 1, v10
    v_or_b32 v15, 1, v11
    v_mov_b32 v9, s47
    v_cmp_eq_u32 vcc, 0, v0
    v_mov_b32 v11, 0x80000000
    s_nop 0
    v_cndmask_b32 v9, v11, v9, vcc
    buffer_store_dwordx2 v[14:15], v9, s[28:31], 0 offen sc1
L_noo:
    s_and_b32 s3, s41, 3
    s_lshl_b32 s3, s3, 6
    v_lshlrev_b32 v9, 4, v3
    v_add_u32 v9, s3, v9
    s_waitcnt lgkmcnt(0)
    ds_read_b128 v[24:27], v9 offset:6656
    s_and_b32 s3, s41, 3
    s_mul_i32 s3, s3, 3072
    s_lshr_b32 s45, s41, 2
    s_mul_i32 s45, s45, 1536
    s_add_u32 s3, s3, s45
    s_add_u32 s3, s3, 9088
    v_lshlrev_b32 v10, 5, v4
    v_add_u32 v10, s3, v10
    v_add_u32 v22, 512, v10
    v_add_u32 v23, 1024, v10
    s_waitcnt lgkmcnt(0)
    v_mfma_f32_16x16x32_bf16 v[224:227], v[24:27], v[160:163], 0
    v_mfma_f32_16x16x32_bf16 v[228:231], v[24:27], v[164:167], 0
    v_mfma_f32_16x16x32_bf16 v[232:235], v[24:27], v[168:171], 0
    v_mfma_f32_16x16x32_bf16 v[236:239], v[24:27], v[172:175], 0
    v_mfma_f32_16x16x32_bf16 v[240:243], v[24:27], v[176:179], 0
    v_mfma_f32_16x16x32_bf16 v[244:247], v[24:27], v[180:183], 0
    v_mfma_f32_16x16x32_bf16 v[248:251], v[24:27], v[184:187], 0
    v_mfma_f32_16x16x32_bf16 v[252:255], v[24:27], v[188:191], 0
    v_mfma_f32_16x16x32_bf16 v[128:131], v[24:27], v[192:195], 0
    v_mfma_f32_16x16x32_bf16 v[132:135], v[24:27], v[196:199], 0
    v_mfma_f32_16x16x32_bf16 v[136:139], v[24:27], v[200:203], 0
    v_mfma_f32_16x16x32_bf16 v[140:143], v[24:27], v[204:207], 0
    v_mfma_f32_16x16x32_bf16 v[144:147], v[24:27], v[208:211], 0
    v_mfma_f32_16x16x32_bf16 v[148:151], v[24:27], v[212:215], 0
    v_mfma_f32_16x16x32_bf16 v[152:155], v[24:27], v[216:219], 0
    v_mfma_f32_16x16x32_bf16 v[156:159], v[24:27], v[220:223], 0
    s_mov_b64 exec, 0xffff
    ds_write2_b32 v10, v224, v228 offset0:0 offset1:1
    ds_write2_b32 v10, v232, v236 offset0:2 offset1:3
    ds_write2_b32 v10, v240, v244 offset0:4 offset1:5
    ds_write2_b32 v10, v248, v252 offset0:6 offset1:7
    s_mov_b64 exec, -1
    v_mfma_f32_16x16x32_bf16 v[160:163], v[24:27], v[96:99], 0
    v_mfma_f32_16x16x32_bf16 v[164:167], v[24:27], v[100:103], 0
    v_mfma_f32_16x16x32_bf16 v[168:171], v[24:27], v[104:107], 0
    v_mfma_f32_16x16x32_bf16 v[172:175], v[24:27], v[108:111], 0
    v_mfma_f32_16x16x32_bf16 v[176:179], v[24:27], v[112:115], 0
    v_mfma_f32_16x16x32_bf16 v[180:183], v[24:27], v[116:119], 0
    v_mfma_f32_16x16x32_bf16 v[184:187], v[24:27], v[120:123], 0
    v_mfma_f32_16x16x32_bf16 v[188:191], v[24:27], v[124:127], 0
    s_mov_b64 exec, 0xffff
    ds_write2_b32 v22, v128, v132 offset0:0 offset1:1
    ds_write2_b32 v22, v136, v140 offset0:2 offset1:3
    ds_write2_b32 v22, v144, v148 offset0:4 offset1:5
    ds_write2_b32 v22, v152, v156 offset0:6 offset1:7
    s_mov_b64 exec, -1
    s_nop 7
    s_nop 1
    s_mov_b64 exec, 0xffff
    ds_write2_b32 v23, v160, v164 offset0:0 offset1:1
    ds_write2_b32 v23, v168, v172 offset0:2 offset1:3
    ds_write2_b32 v23, v176, v180 offset0:4 offset1:5
    ds_write2_b32 v23, v184, v188 offset0:6 offset1:7
    s_mov_b64 exec, -1
    s_waitcnt lgkmcnt(0)
    s_barrier
    v_lshrrev_b32 v9, 2, v0
    s_mul_i32 s3, s38, 40
    v_add_u32 v9, s3, v9
    v_lshlrev_b32 v9, 13, v9
    s_lshl_b32 s3, s42, 6
    v_add_u32 v9, s3, v9
    v_and_b32 v10, 3, v0
    v_lshlrev_b32 v10, 4, v10
    v_add_u32 v9, v9, v10
    v_cmp_gt_u32 vcc, 160, v0
    v_mov_b32 v11, 0x80000000
    s_nop 0
    v_cndmask_b32 v9, v11, v9, vcc
    s_cmp_ge_u32 s41, 3
    s_cbranch_scc1 L_noy
    v_lshlrev_b32 v10, 4, v0
    ds_read_b128 v[224:227], v10 offset:9088
    ds_read_b128 v[228:231], v10 offset:12160
    ds_read_b128 v[232:235], v10 offset:15232
    ds_read_b128 v[236:239], v10 offset:18304
    s_waitcnt lgkmcnt(0)
    v_add_f32 v224, v224, v228
    v_add_f32 v232, v232, v236
    v_add_f32 v224, v224, v232
    v_or_b32 v224, 1, v224
    v_add_f32 v225, v225, v229
    v_add_f32 v233, v233, v237
    v_add_f32 v225, v225, v233
    v_or_b32 v225, 1, v225
    v_add_f32 v226, v226, v230
    v_add_f32 v234, v234, v238
    v_add_f32 v226, v226, v234
    v_or_b32 v226, 1, v226
    v_add_f32 v227, v227, v231
    v_add_f32 v235, v235, v239
    v_add_f32 v227, v227, v235
    v_or_b32 v227, 1, v227
    buffer_store_dwordx4 v[224:227], v9, s[28:31], 0 offen sc1
L_noy:
    s_cmp_ge_u32 s2, 174
    s_cbranch_scc1 L_end
    s_waitcnt vmcnt(16)
    s_mov_b32 s52, 0
L_cchk:
    v_readfirstlane_b32 s3, v30
    s_cmp_eq_u32 s3, 256
    s_cbranch_scc1 L_cok
    s_add_u32 s52, s52, 1
    s_cmp_gt_u32 s52, 20000
    s_cbranch_scc1 L_cok
    v_mov_b32 v9, 0
    global_load_dword v30, v9, s[36:37] sc1
    s_waitcnt vmcnt(0)
    s_branch L_cchk
L_cok:
    s_cmp_ge_u32 s2, 134
    s_cbranch_scc1 L_hopC
    s_cmp_ge_u32 s2, 80
    s_cbranch_scc1 L_ffn
    s_cmp_ge_u32 s2, 40
    s_cselect_b32 s48, 1, 0
    s_lshl_b32 s3, s2, 13
    v_lshlrev_b32 v9, 4, v0
    v_add_u32 v9, s3, v9
    s_lshl_b32 s3, s48, 10
    s_add_u32 s3, s3, 655360
    v_lshrrev_b32 v10, 4, v0
    v_lshlrev_b32 v10, 5, v10
    v_add_u32 v10, s3, v10
    v_lshrrev_b32 v28, 2, v0
    v_lshlrev_b32 v28, 3, v28
    v_add_u32 v28, s3, v28
    s_lshl_b32 s3, s48, 0
    s_sub_u32 s3, s3, s38
    s_mul_i32 s3, s3, 1280
    s_mul_i32 s45, s48, 40
    s_sub_u32 s45, s2, s45
    s_lshl_b32 s45, s45, 5
    s_add_u32 s3, s3, s45
    s_ashr_i32 s45, s3, 31
    s_add_u32 s58, s32, s3
    s_addc_u32 s59, s33, s45
    v_lshlrev_b32 v29, 1, v4
    global_load_ushort v27, v29, s[58:59]
    v_lshrrev_b32 v12, 4, v0
    v_lshlrev_b32 v12, 6, v12
    v_lshl_add_u32 v96, v4, 4, v12
    v_cmp_gt_u32 s[56:57], 4, v4
    v_lshlrev_b32 v12, 9, v3
    v_lshl_add_u32 v97, v4, 2, v12
    s_lshl_b32 s3, s2, 6
    s_add_u32 s3, s3, 659456
    v_lshlrev_b32 v12, 2, v4
    v_add_u32 v12, s3, v12
    v_cmp_gt_u32 vcc, 16, v1
    v_mov_b32 v11, 0x80000000
    s_nop 0
    v_cndmask_b32 v12, v11, v12, vcc
    v_mov_b32 v98, v12
    s_mov_b32 s52, 0
L_poll_1:
    buffer_load_dwordx4 v[12:15], v9, s[28:31], 0 offen sc1
    buffer_load_dwordx4 v[16:19], v10, s[28:31], 0 offen sc1
    buffer_load_dwordx4 v[20:23], v10, s[28:31], 0 offen offset:16 sc1
    buffer_load_dwordx2 v[24:25], v28, s[28:31], 0 offen sc1
    s_waitcnt vmcnt(0)
    v_and_b32 v11, v12, v13
    v_and_b32 v11, v11, v14
    v_and_b32 v11, v11, v15
    v_and_b32 v11, v11, v16
    v_and_b32 v11, v11, v17
    v_and_b32 v11, v11, v18
    v_and_b32 v11, v11, v19
    v_and_b32 v11, v11, v20
    v_and_b32 v11, v11, v21
    v_and_b32 v11, v11, v22
    v_and_b32 v11, v11, v23
    v_and_b32 v11, v11, v24
    v_and_b32 v11, v11, v25
    v_and_b32 v11, 1, v11
    v_cmp_ne_u32 vcc, 1, v11
    s_add_u32 s52, s52, 1
    s_cmp_gt_u32 s52, 20000
    s_cbranch_scc1 L_done_2
    s_nop 1
    s_and_b64 exec, exec, vcc
    s_cbranch_scc1 L_poll_1
L_done_2:
    s_mov_b64 exec, -1
    v_max3_f32 v10, v16, v18, v20
    v_max_f32 v10, v10, v22
    v_sub_f32 v16, v16, v10
    v_sub_f32 v18, v18, v10
    v_sub_f32 v20, v20, v10
    v_sub_f32 v22, v22, v10
    v_sub_f32 v24, v24, v10
    v_exp_f32 v16, v16
    v_exp_f32 v18, v18
    v_exp_f32 v20, v20
    v_exp_f32 v22, v22
    v_exp_f32 v24, v24
    s_nop 0
    v_mul_f32 v11, v16, v17
    v_fmac_f32 v11, v18, v19
    v_fmac_f32 v11, v20, v21
    v_fmac_f32 v11, v22, v23
    v_rcp_f32 v11, v11
    v_mul_f32 v24, v24, v25
    s_nop 0
    v_mul_f32 v24, v24, v11
    v_mul_f32 v12, v12, v24
    v_mul_f32 v13, v13, v24
    v_mul_f32 v14, v14, v24
    v_mul_f32 v15, v15, v24
    s_nop 1
    v_add_f32_dpp v12, v12, v12 row_ror:4 row_mask:0xf bank_mask:0xf
    v_add_f32_dpp v13, v13, v13 row_ror:4 row_mask:0xf bank_mask:0xf
    v_add_f32_dpp v14, v14, v14 row_ror:4 row_mask:0xf bank_mask:0xf
    v_add_f32_dpp v15, v15, v15 row_ror:4 row_mask:0xf bank_mask:0xf
    s_nop 1
    v_add_f32_dpp v12, v12, v12 row_ror:8 row_mask:0xf bank_mask:0xf
    v_add_f32_dpp v13, v13, v13 row_ror:8 row_mask:0xf bank_mask:0xf
    v_add_f32_dpp v14, v14, v14 row_ror:8 row_mask:0xf bank_mask:0xf
    v_add_f32_dpp v15, v15, v15 row_ror:8 row_mask:0xf bank_mask:0xf
    s_mov_b64 exec, s[56:57]
    ds_write_b128 v96, v[12:15] offset:21376
    s_mov_b64 exec, -1
    v_lshlrev_b32 v27, 16, v27
    s_waitcnt lgkmcnt(0)
    s_barrier
    s_cmp_lg_u32 s41, 0
    s_cbranch_scc1 L_end
    ds_read_b32 v12, v97 offset:21376
    ds_read_b32 v13, v97 offset:21440
    ds_read_b32 v14, v97 offset:21504
    ds_read_b32 v15, v97 offset:21568
    ds_read_b32 v16, v97 offset:21632
    ds_read_b32 v17, v97 offset:21696
    ds_read_b32 v18, v97 offset:21760
    ds_read_b32 v19, v97 offset:21824
    s_waitcnt lgkmcnt(0)
    v_pk_add_f32 v[12:13], v[12:13], v[14:15]
    v_pk_add_f32 v[16:17], v[16:17], v[18:19]
    s_nop 0
    v_pk_add_f32 v[12:13], v[12:13], v[16:17]
    s_nop 0
    v_add_f32 v12, v12, v13
    v_mov_b32 v13, v12
    s_nop 1
    v_permlane16_swap_b32 v12, v13
    s_nop 1
    v_add_f32 v12, v12, v13
    v_mov_b32 v13, v12
    s_nop 1
    v_permlane32_swap_b32 v12, v13
    s_nop 1
    v_add_f32 v12, v12, v13
    v_cvt_pk_bf16_f32 v12, v12, v12
    v_and_b32 v12, 0xffff0000, v12
    v_add_f32 v12, v12, v27
    v_cvt_pk_bf16_f32 v12, v12, v12
    v_and_b32 v12, 0xffff0000, v12
    v_or_b32 v12, 1, v12
    buffer_store_dword v12, v98, s[28:31], 0 offen sc1
    s_branch L_end
L_ffn:
    s_cmp_ge_u32 s41, 5
    s_cbranch_scc1 L_ffn_idle0
    s_sub_u32 s48, s2, 80
    v_lshrrev_b32 v12, 5, v1
    v_and_b32 v13, 31, v1
    v_mul_u32_u24 v9, 2560, v12
    v_lshl_add_u32 v9, v13, 4, v9
    s_lshl_b32 s3, s41, 9
    s_add_u32 s3, s3, 659456
    v_add_u32 v96, s3, v9
    v_lshlrev_b32 v98, 3, v12
    s_lshl_b32 s3, s41, 4
    v_add_u32 v97, s3, v98
    v_mul_u32_u24 v9, 1280, v12
    v_lshl_add_u32 v9, v13, 3, v9
    s_lshl_b32 s3, s41, 8
    v_add_u32 v99, s3, v9
    v_and_b32 v14, 1, v4
    v_lshrrev_b32 v15, 2, v4
    v_and_b32 v16, 3, v4
    v_mul_u32_u24 v9, 1280, v14
    v_lshl_add_u32 v9, v15, 6, v9
    v_lshl_add_u32 v9, v3, 4, v9
    v_add_u32 v100, s3, v9
    v_cmp_eq_u32 s[56:57], v15, v3
    v_cmp_eq_u32 s[50:51], 1, v3
    v_lshlrev_b32 v9, 8, v15
    v_lshl_add_u32 v9, v16, 5, v9
    s_lshl_b32 s3, s41, 10
    s_add_u32 s3, s3, 21376
    v_add_u32 v101, s3, v9
    v_lshlrev_b32 v9, 2, v1
    v_add_u32 v102, 21376, v9
    v_lshlrev_b32 v103, 1, v1
    v_lshlrev_b32 v9, 6, v14
    v_lshl_add_u32 v104, v3, 4, v9
    v_mul_u32_u24 v9, 20, v3
    v_add_u32 v9, v9, v15
    s_lshl_b32 s3, s41, 2
    v_add_u32 v9, s3, v9
    v_mul_u32_u24 v9, 54, v9
    v_add_u32 v9, s48, v9
    v_lshlrev_b32 v9, 7, v9
    v_lshl_add_u32 v9, v16, 5, v9
    v_add_u32 v9, 671744, v9
    v_cmp_gt_u32 vcc, 32, v1
    v_mov_b32 v11, 0x80000000
    s_nop 0
    v_cndmask_b32 v9, v11, v9, vcc
    v_mov_b32 v105, v9
    s_mov_b32 s54, 0x80000000
    s_mov_b32 s55, 0x80000000
    s_waitcnt vmcnt(0)
    v_perm_b32 v128, v36, v32, s43
    v_perm_b32 v129, v44, v40, s43
    v_perm_b32 v130, v52, v48, s43
    v_perm_b32 v131, v60, v56, s43
    v_perm_b32 v132, v36, v32, s44
    v_perm_b32 v133, v44, v40, s44
    v_perm_b32 v134, v52, v48, s44
    v_perm_b32 v135, v60, v56, s44
    v_perm_b32 v136, v37, v33, s43
    v_perm_b32 v137, v45, v41, s43
    v_perm_b32 v138, v53, v49, s43
    v_perm_b32 v139, v61, v57, s43
    v_perm_b32 v140, v37, v33, s44
    v_perm_b32 v141, v45, v41, s44
    v_perm_b32 v142, v53, v49, s44
    v_perm_b32 v143, v61, v57, s44
    v_perm_b32 v144, v38, v34, s43
    v_perm_b32 v145, v46, v42, s43
    v_perm_b32 v146, v54, v50, s43
    v_perm_b32 v147, v62, v58, s43
    v_perm_b32 v148, v38, v34, s44
    v_perm_b32 v149, v46, v42, s44
    v_perm_b32 v150, v54, v50, s44
    v_perm_b32 v151, v62, v58, s44
    v_perm_b32 v152, v39, v35, s43
    v_perm_b32 v153, v47, v43, s43
    v_perm_b32 v154, v55, v51, s43
    v_perm_b32 v155, v63, v59, s43
    v_perm_b32 v156, v39, v35, s44
    v_perm_b32 v157, v47, v43, s44
    v_perm_b32 v158, v55, v51, s44
    v_perm_b32 v159, v63, v59, s44
    v_perm_b32 v160, v68, v64, s43
    v_perm_b32 v161, v76, v72, s43
    v_perm_b32 v162, v84, v80, s43
    v_perm_b32 v163, v92, v88, s43
    v_perm_b32 v164, v68, v64, s44
    v_perm_b32 v165, v76, v72, s44
    v_perm_b32 v166, v84, v80, s44
    v_perm_b32 v167, v92, v88, s44
    v_perm_b32 v168, v69, v65, s43
    v_perm_b32 v169, v77, v73, s43
    v_perm_b32 v170, v85, v81, s43
    v_perm_b32 v171, v93, v89, s43
    v_perm_b32 v172, v69, v65, s44
    v_perm_b32 v173, v77, v73, s44
    v_perm_b32 v174, v85, v81, s44
    v_perm_b32 v175, v93, v89, s44
    v_perm_b32 v176, v70, v66, s43
    v_perm_b32 v177, v78, v74, s43
    v_perm_b32 v178, v86, v82, s43
    v_perm_b32 v179, v94, v90, s43
    v_perm_b32 v180, v70, v66, s44
    v_perm_b32 v181, v78, v74, s44
    v_perm_b32 v182, v86, v82, s44
    v_perm_b32 v183, v94, v90, s44
    v_perm_b32 v184, v71, v67, s43
    v_perm_b32 v185, v79, v75, s43
    v_perm_b32 v186, v87, v83, s43
    v_perm_b32 v187, v95, v91, s43
    v_perm_b32 v188, v71, v67, s44
    v_perm_b32 v189, v79, v75, s44
    v_perm_b32 v190, v87, v83, s44
    v_perm_b32 v191, v95, v91, s44
    s_mov_b32 s52, 0
L_poll_3:
    buffer_load_dwordx4 v[32:35], v96, s[28:31], 0 offen sc1
    s_waitcnt vmcnt(0)
    v_and_b32 v11, v32, v33
    v_and_b32 v11, v11, v34
    v_and_b32 v11, v11, v35
    v_and_b32 v11, 1, v11
    v_cmp_ne_u32 vcc, 1, v11
    s_add_u32 s52, s52, 1
    s_cmp_gt_u32 s52, 20000
    s_cbranch_scc1 L_done_4
    s_nop 1
    s_and_b64 exec, exec, vcc
    s_cbranch_scc1 L_poll_3
L_done_4:
    s_mov_b64 exec, -1
    v_and_b32 v32, 0xffff0000, v32
    v_and_b32 v33, 0xffff0000, v33
    v_and_b32 v34, 0xffff0000, v34
    v_and_b32 v35, 0xffff0000, v35
    v_pk_mul_f32 v[12:13], v[32:33], v[32:33]
    v_pk_add_f32 v[14:15], v[32:33], v[34:35]
    v_pk_fma_f32 v[12:13], v[34:35], v[34:35], v[12:13]
    v_add_f32 v16, v14, v15
    v_add_f32 v17, v12, v13
    s_nop 0
    v_add_f32_dpp v16, v16, v16 row_ror:8 row_mask:0xf bank_mask:0xf
    v_add_f32_dpp v17, v17, v17 row_ror:8 row_mask:0xf bank_mask:0xf
    s_nop 0
    v_add_f32_dpp v16, v16, v16 row_ror:4 row_mask:0xf bank_mask:0xf
    v_add_f32_dpp v17, v17, v17 row_ror:4 row_mask:0xf bank_mask:0xf
    s_nop 0
    v_add_f32_dpp v16, v16, v16 row_ror:2 row_mask:0xf bank_mask:0xf
    v_add_f32_dpp v17, v17, v17 row_ror:2 row_mask:0xf bank_mask:0xf
    s_nop 0
    v_add_f32_dpp v16, v16, v16 row_ror:1 row_mask:0xf bank_mask:0xf
    v_add_f32_dpp v17, v17, v17 row_ror:1 row_mask:0xf bank_mask:0xf
    s_nop 0
    v_add_f32_dpp v16, v16, v16 row_bcast:15 row_mask:0xa bank_mask:0xf
    v_add_f32_dpp v17, v17, v17 row_bcast:15 row_mask:0xa bank_mask:0xf
    s_mov_b64 exec, s[54:55]
    ds_write_b64 v97, v[16:17] offset:9088
    s_mov_b64 exec, -1
    s_waitcnt lgkmcnt(0)
L_ffn_idle0:
    s_barrier
    s_cmp_ge_u32 s41, 5
    s_cbranch_scc1 L_ffn_idle
    ds_read_b64 v[12:13], v98 offset:9088
    ds_read_b64 v[14:15], v98 offset:9104
    ds_read_b64 v[16:17], v98 offset:9120
    ds_read_b64 v[18:19], v98 offset:9136
    ds_read_b64 v[20:21], v98 offset:9152
    s_waitcnt lgkmcnt(0)
    v_pk_add_f32 v[12:13], v[12:13], v[14:15]
    v_pk_add_f32 v[16:17], v[16:17], v[18:19]
    v_pk_add_f32 v[12:13], v[12:13], v[20:21]
    s_nop 0
    v_pk_add_f32 v[12:13], v[12:13], v[16:17]
    v_mul_f32 v13, 0x3acccccd, v13
    v_mul_f32 v12, 0x3acccccd, v12
    v_fma_f32 v14, -v12, v12, v13
    v_max_f32 v14, 0, v14
    v_cvt_pk_bf16_f32 v14, v14, v14
    v_and_b32 v14, 0xffff0000, v14
    v_add_f32 v14, 0x3727c5ac, v14
    v_cvt_pk_bf16_f32 v14, v14, v14
    v_and_b32 v14, 0xffff0000, v14
    v_sqrt_f32 v14, v14
    v_cvt_pk_bf16_f32 v13, v12, v12
    v_and_b32 v13, 0xffff0000, v13
    v_cvt_pk_bf16_f32 v14, v14, v14
    v_and_b32 v14, 0xffff0000, v14
    v_rcp_f32 v15, v14
    v_sub_f32 v32, v32, v13
    v_sub_f32 v33, v33, v13
    v_sub_f32 v34, v34, v13
    v_sub_f32 v35, v35, v13
    v_cvt_pk_bf16_f32 v32, v32, v32
    v_cvt_pk_bf16_f32 v33, v33, v33
    v_cvt_pk_bf16_f32 v34, v34, v34
    v_cvt_pk_bf16_f32 v35, v35, v35
    v_and_b32 v32, 0xffff0000, v32
    v_and_b32 v33, 0xffff0000, v33
    v_and_b32 v34, 0xffff0000, v34
    v_and_b32 v35, 0xffff0000, v35
    v_mul_f32 v16, v32, v15
    v_mul_f32 v17, v33, v15
    v_mul_f32 v18, v34, v15
    v_mul_f32 v19, v35, v15
    v_fma_f32 v20, -v16, v14, v32
    v_fma_f32 v21, -v17, v14, v33
    v_fma_f32 v22, -v18, v14, v34
    v_fma_f32 v23, -v19, v14, v35
    v_fma_f32 v32, v20, v15, v16
    v_fma_f32 v33, v21, v15, v17
    v_fma_f32 v34, v22, v15, v18
    v_fma_f32 v35, v23, v15, v19
    v_cvt_pk_bf16_f32 v12, v32, v33
    v_cvt_pk_bf16_f32 v13, v34, v35
    ds_write_b64 v99, v[12:13] offset:0
    s_waitcnt lgkmcnt(0)
    ds_read_b128 v[24:27], v100 offset:0
    s_waitcnt lgkmcnt(0)
    v_mfma_f32_16x16x32_bf16 v[224:227], v[24:27], v[128:131], 0
    v_mfma_f32_16x16x32_bf16 v[228:231], v[24:27], v[132:135], 0
    v_mfma_f32_16x16x32_bf16 v[232:235], v[24:27], v[136:139], 0
    v_mfma_f32_16x16x32_bf16 v[236:239], v[24:27], v[140:143], 0
    v_mfma_f32_16x16x32_bf16 v[240:243], v[24:27], v[144:147], 0
    v_mfma_f32_16x16x32_bf16 v[244:247], v[24:27], v[148:151], 0
    v_mfma_f32_16x16x32_bf16 v[248:251], v[24:27], v[152:155], 0
    v_mfma_f32_16x16x32_bf16 v[252:255], v[24:27], v[156:159], 0
    s_mov_b64 exec, s[56:57]
    s_nop 4
    ds_write2_b32 v101, v224, v228 offset0:0 offset1:1
    ds_write2_b32 v101, v225, v229 offset0:32 offset1:33
    ds_write2_b32 v101, v232, v236 offset0:2 offset1:3
    ds_write2_b32 v101, v233, v237 offset0:34 offset1:35
    ds_write2_b32 v101, v240, v244 offset0:4 offset1:5
    ds_write2_b32 v101, v241, v245 offset0:36 offset1:37
    ds_write2_b32 v101, v248, v252 offset0:6 offset1:7
    ds_write2_b32 v101, v249, v253 offset0:38 offset1:39
    s_mov_b64 exec, -1
    s_waitcnt lgkmcnt(0)
L_ffn_idle:
    s_barrier
    s_cmp_ge_u32 s41, 5
    s_cbranch_scc1 L_end
    ds_read2st64_b32 v[224:225], v102 offset0:0 offset1:1
    ds_read2st64_b32 v[226:227], v102 offset0:2 offset1:3
    ds_read2st64_b32 v[228:229], v102 offset0:4 offset1:5
    ds_read2st64_b32 v[230:231], v102 offset0:6 offset1:7
    ds_read2st64_b32 v[232:233], v102 offset0:8 offset1:9
    ds_read2st64_b32 v[234:235], v102 offset0:10 offset1:11
    ds_read2st64_b32 v[236:237], v102 offset0:12 offset1:13
    ds_read2st64_b32 v[238:239], v102 offset0:14 offset1:15
    ds_read2st64_b32 v[240:241], v102 offset0:16 offset1:17
    ds_read2st64_b32 v[242:243], v102 offset0:18 offset1:19
    s_waitcnt lgkmcnt(0)
    v_pk_add_f32 v[224:225], v[224:225], v[234:235]
    v_pk_add_f32 v[226:227], v[226:227], v[236:237]
    v_pk_add_f32 v[228:229], v[228:229], v[238:239]
    v_pk_add_f32 v[230:231], v[230:231], v[240:241]
    v_pk_add_f32 v[232:233], v[232:233], v[242:243]
    v_pk_add_f32 v[224:225], v[224:225], v[226:227]
    v_pk_add_f32 v[228:229], v[228:229], v[230:231]
    v_pk_add_f32 v[224:225], v[224:225], v[232:233]
    s_nop 0
    v_pk_add_f32 v[224:225], v[224:225], v[228:229]
    v_add_f32 v224, v224, v225
    v_max_f32 v224, 0, v224
    v_cvt_pk_bf16_f32 v12, v224, v224
    ds_write_b16 v103, v12 offset:6656
    s_waitcnt lgkmcnt(0)
    ds_read_b128 v[24:27], v104 offset:6656
    s_waitcnt lgkmcnt(0)
    v_mfma_f32_16x16x32_bf16 v[224:227], v[24:27], v[160:163], 0
    v_mfma_f32_16x16x32_bf16 v[228:231], v[24:27], v[164:167], 0
    v_mfma_f32_16x16x32_bf16 v[232:235], v[24:27], v[168:171], 0
    v_mfma_f32_16x16x32_bf16 v[236:239], v[24:27], v[172:175], 0
    v_mfma_f32_16x16x32_bf16 v[240:243], v[24:27], v[176:179], 0
    v_mfma_f32_16x16x32_bf16 v[244:247], v[24:27], v[180:183], 0
    v_mfma_f32_16x16x32_bf16 v[248:251], v[24:27], v[184:187], 0
    v_mfma_f32_16x16x32_bf16 v[252:255], v[24:27], v[188:191], 0
    s_nop 3
    v_cndmask_b32 v12, v224, v225, s[50:51]
    v_or_b32 v12, 1, v12
    v_cndmask_b32 v13, v228, v229, s[50:51]
    v_or_b32 v13, 1, v13
    v_cndmask_b32 v14, v232, v233, s[50:51]
    v_or_b32 v14, 1, v14
    v_cndmask_b32 v15, v236, v237, s[50:51]
    v_or_b32 v15, 1, v15
    buffer_store_dwordx4 v[12:15], v105, s[28:31], 0 offen sc1
    v_cndmask_b32 v16, v240, v241, s[50:51]
    v_or_b32 v16, 1, v16
    v_cndmask_b32 v17, v244, v245, s[50:51]
    v_or_b32 v17, 1, v17
    v_cndmask_b32 v18, v248, v249, s[50:51]
    v_or_b32 v18, 1, v18
    v_cndmask_b32 v19, v252, v253, s[50:51]
    v_or_b32 v19, 1, v19
    buffer_store_dwordx4 v[16:19], v105, s[28:31], 0 offen offset:16 sc1
    s_branch L_end
L_hopC:
    s_sub_u32 s48, s2, 134
    s_mul_i32 s3, s48, 6912
    s_add_u32 s3, s3, 671744
    v_lshlrev_b32 v9, 4, v0
    v_add_u32 v9, s3, v9
    v_cmp_gt_u32 vcc, 432, v0
    v_mov_b32 v11, 0x80000000
    s_nop 0
    v_cndmask_b32 v9, v11, v9, vcc
    v_cmp_le_u32 vcc, 432, v0
    s_nop 1
    v_cndmask_b32 v28, 0, 1, vcc
    s_lshl_b32 s3, s48, 7
    s_add_u32 s3, s3, 659456
    v_and_b32 v10, 31, v1
    v_lshl_add_u32 v10, v10, 2, s3
    v_lshrrev_b32 v12, 4, v0
    v_lshlrev_b32 v12, 7, v12
    v_lshl_add_u32 v96, v4, 4, v12
    v_cmp_gt_u32 s[56:57], 8, v4
    v_lshrrev_b32 v12, 5, v1
    v_lshlrev_b32 v12, 11, v12
    v_and_b32 v13, 31, v1
    v_lshl_add_u32 v12, v13, 2, v12
    v_add_u32 v97, 21376, v12
    v_add_u32 v99, 21504, v12
    s_lshl_b32 s3, s48, 6
    v_lshlrev_b32 v12, 1, v13
    v_add_u32 v98, s3, v12
    s_mov_b32 s52, 0
L_poll_5:
    buffer_load_dwordx4 v[12:15], v9, s[28:31], 0 offen sc1
    s_waitcnt vmcnt(0)
    v_and_b32 v11, v12, v13
    v_and_b32 v11, v11, v14
    v_and_b32 v11, v11, v15
    v_or_b32 v11, v11, v28
    v_and_b32 v11, 1, v11
    v_cmp_ne_u32 vcc, 1, v11
    s_add_u32 s52, s52, 1
    s_cmp_gt_u32 s52, 20000
    s_cbranch_scc1 L_done_6
    s_nop 1
    s_and_b64 exec, exec, vcc
    s_cbranch_scc1 L_poll_5
L_done_6:
    s_mov_b64 exec, -1
    buffer_load_dword v27, v10, s[28:31], 0 offen sc1
    s_nop 1
    v_add_f32_dpp v12, v12, v12 row_ror:8 row_mask:0xf bank_mask:0xf
    v_add_f32_dpp v13, v13, v13 row_ror:8 row_mask:0xf bank_mask:0xf
    v_add_f32_dpp v14, v14, v14 row_ror:8 row_mask:0xf bank_mask:0xf
    v_add_f32_dpp v15, v15, v15 row_ror:8 row_mask:0xf bank_mask:0xf
    s_mov_b64 exec, s[56:57]
    ds_write_b128 v96, v[12:15] offset:21376
    s_mov_b64 exec, -1
    s_waitcnt lgkmcnt(0)
    s_barrier
    s_cmp_lg_u32 s41, 0
    s_cbranch_scc1 L_end
    ds_read2st64_b32 v[224:225], v97 offset0:0 offset1:1
    ds_read2st64_b32 v[226:227], v99 offset0:0 offset1:1
    ds_read2st64_b32 v[228:229], v97 offset0:2 offset1:3
    ds_read2st64_b32 v[230:231], v99 offset0:2 offset1:3
    ds_read2st64_b32 v[232:233], v97 offset0:4 offset1:5
    ds_read2st64_b32 v[234:235], v99 offset0:4 offset1:5
    ds_read2st64_b32 v[236:237], v97 offset0:6 offset1:7
    ds_read2st64_b32 v[238:239], v99 offset0:6 offset1:7
    s_waitcnt lgkmcnt(0)
    v_pk_add_f32 v[224:225], v[224:225], v[232:233]
    v_pk_add_f32 v[226:227], v[226:227], v[234:235]
    v_pk_add_f32 v[228:229], v[228:229], v[236:237]
    v_pk_add_f32 v[230:231], v[230:231], v[238:239]
    v_pk_add_f32 v[224:225], v[224:225], v[228:229]
    v_pk_add_f32 v[226:227], v[226:227], v[230:231]
    s_nop 0
    v_pk_add_f32 v[224:225], v[224:225], v[226:227]
    s_nop 0
    v_add_f32 v224, v224, v225
    v_mov_b32 v225, v224
    s_nop 1
    v_permlane32_swap_b32 v224, v225
    s_nop 1
    v_add_f32 v224, v224, v225
    s_waitcnt vmcnt(0)
    v_cvt_pk_bf16_f32 v224, v224, v224
    v_and_b32 v224, 0xffff0000, v224
    v_and_b32 v27, 0xffff0000, v27
    v_add_f32 v224, v224, v27
    v_cvt_pk_bf16_f32 v12, v224, v224
    s_mov_b64 exec, 0xffffffff
    global_store_short v98, v12, s[34:35]
    s_mov_b64 exec, -1
L_end:
L_end2:
    s_endpgm
.section .rodata,"a"
.p2align 6
.amdhsa_kernel sequential_preLN__gqa_block_cached__dense_activation_relu__decode_kernel
  .amdhsa_next_free_vgpr 256
  .amdhsa_next_free_sgpr 102
  .amdhsa_accum_offset 256
  .amdhsa_group_segment_fixed_size 0
  .amdhsa_kernarg_size 88
  .amdhsa_user_sgpr_count 2
  .amdhsa_user_sgpr_kernarg_segment_ptr 1
  .amdhsa_system_sgpr_workgroup_id_x 1
.end_amdhsa_kernel
```
